```python
import torch

def _softmax(x, axis=-1):
    return torch.softmax(x, dim=axis)
def _gelu(x):
    return torch.nn.functional.gelu(x, approximate="tanh")
def _silu(x):
    return torch.nn.functional.silu(x)
def _sigmoid(x):
    return torch.sigmoid(x)
def _layernorm(x, axis=-1, eps=1e-5):
    m = x.mean(dim=axis, keepdim=True)
    v = x.var(dim=axis, keepdim=True, unbiased=False)
    return (x - m) / torch.sqrt(v + eps)
def _scatter_add(tgt, idx, src, axis=0):
    return tgt.clone().index_add_(axis, idx, src)
def _segment_sum(src, seg, n):
    out = torch.zeros((n,) + src.shape[1:], dtype=src.dtype)
    return out.index_add_(0, seg, src)
def _pad(x, pw):
    flat = tuple(v for pair in reversed(pw) for v in pair)
    return torch.nn.functional.pad(x, flat)

kernel_name = 'gated_mix__spectral_fnet__dense_activation_relu__prompt'

def setup_inputs():

    _w = (lambda a: (lambda t: t.to(torch.bfloat16) if t.is_floating_point() else t)(torch.as_tensor(a)))
    def _A_setup():
        B, S, D = 1, 2048, 576
        ns = torch.arange(S)[:, None] * torch.arange(S)[None, :]
        nd = torch.arange(D)[:, None] * torch.arange(D)[None, :]
        Ws_re = torch.cos(-2.0 * torch.pi * ns / S).to(float)
        Ws_im = torch.sin(-2.0 * torch.pi * ns / S).to(float)
        Wd_re = torch.cos(-2.0 * torch.pi * nd / D).to(float)
        Wd_im = torch.sin(-2.0 * torch.pi * nd / D).to(float)
        return {
            "x": _w((lambda *s: torch.randn(*s, dtype=torch.bfloat16) * 0.05)(B, S, D)),
            "dft_seq_re": _w(Ws_re),
            "dft_seq_im": _w(Ws_im),
            "dft_hid_re": _w(Wd_re),
            "dft_hid_im": _w(Wd_im),
        }
    _A_in = _A_setup()

    def _B_setup():
        B, S, D, Dff = 1, 2048, 576, 4608
        return {
            "x": _w((lambda *s: torch.randn(*s, dtype=torch.bfloat16) * 0.05)(B, S, D)),
            "w1": _w((lambda *s: torch.randn(*s, dtype=torch.bfloat16) * 0.4)(D, Dff)),
            "w2": _w((lambda *s: torch.randn(*s, dtype=torch.bfloat16) * 0.4)(Dff, D)),
        }
    _B_in = _B_setup()

    return {
        "A_x": _A_in["x"],
        "A_dft_seq_re": _A_in["dft_seq_re"],
        "A_dft_seq_im": _A_in["dft_seq_im"],
        "A_dft_hid_re": _A_in["dft_hid_re"],
        "A_dft_hid_im": _A_in["dft_hid_im"],
        "B_x": _B_in["x"],
        "B_w1": _B_in["w1"],
        "B_w2": _B_in["w2"],
        "gate_w": _w((lambda *s: torch.randn(*s, dtype=torch.bfloat16) * 0.05)(576) * 16.0),
    }

def reference(A_x, A_dft_seq_re, A_dft_seq_im, A_dft_hid_re, A_dft_hid_im, B_x, B_w1, B_w2, gate_w):
    def _A_ref(x, dft_seq_re, dft_seq_im, dft_hid_re, dft_hid_im):
        a = torch.einsum("bsd,ed->bse", x, dft_hid_re)
        b = torch.einsum("bsd,ed->bse", x, dft_hid_im)
        y = torch.einsum("ts,bse->bte", dft_seq_re, a) - torch.einsum("ts,bse->bte", dft_seq_im, b)
        return y

    def _B_ref(x, w1, w2):
        h = torch.einsum("bsd,df->bsf", x, w1)
        zero = torch.zeros_like(h)
        h = torch.maximum(h, zero)
        return torch.einsum("bsf,fd->bsd", h, w2)

    x = A_x
    g = _sigmoid((x * gate_w).sum(-1, keepdims=True))
    a = _A_ref(x, A_dft_seq_re, A_dft_seq_im, A_dft_hid_re, A_dft_hid_im)
    b = _B_ref(x, B_w1, B_w2)
    return g * a + (1 - g) * b
```

```asm
; @launch grid=(256,1,1) block=(256,1,1) lds=163840
.amdgcn_target "amdgcn-amd-amdhsa--gfx950"
.text
.globl gated_mix__spectral_fnet__dense_activation_relu__prompt_kernel
.p2align 8
.type gated_mix__spectral_fnet__dense_activation_relu__prompt_kernel,@function
gated_mix__spectral_fnet__dense_activation_relu__prompt_kernel:
    s_cmp_ge_u32 s2, 256
    s_cbranch_scc1 L_end
    s_load_dwordx16 s[36:51], s[0:1], 0
    s_load_dwordx8 s[52:59], s[0:1], 64
    v_lshrrev_b32 v4, 6, v0
    v_and_b32 v1, 63, v0
    v_readfirstlane_b32 s3, v4
    v_and_b32 v2, 15, v0
    v_bfe_u32 v3, v0, 4, 2
    s_and_b32 s60, s2, 3
    s_bfe_u32 s61, s2, 0x10002
    s_lshr_b32 s62, s2, 3
    s_and_b32 s63, s2, 7
    s_cmp_ge_u32 s63, 6
    s_cselect_b32 s63, 30, 29
    s_cmp_ge_u32 s62, s63
    s_cbranch_scc1 L_spare
    s_mul_i32 s65, s60, 3
    s_add_u32 s64, s65, s62
    s_sub_u32 s64, s64, 26
    s_lshl_b32 s5, s60, 1
    s_cmp_ge_u32 s62, 13
    s_cselect_b32 s65, 13, 0
    s_cselect_b32 s66, 1, 0
    s_add_u32 s5, s5, s66
    s_sub_u32 s4, s62, s65
    s_cmp_lt_u32 s62, 26
    s_cselect_b32 s4, s4, s64
    s_cselect_b32 s5, s5, 8
    s_mul_i32 s65, s61, 13
    s_add_u32 s4, s4, s65
    s_cmp_eq_u32 s2, 238
    s_cselect_b32 s4, 12, s4
    v_lshrrev_b32 v4, 3, v1
    v_bfe_u32 v5, v1, 4, 1
    v_lshrrev_b32 v6, 5, v1
    s_mul_i32 s65, s4, 20
    v_mul_u32_u24 v9, 511, v5
    v_add3_u32 v6, v6, v9, s65
    s_and_b32 s66, s3, 1
    s_lshl_b32 s66, s66, 2
    v_add_u32 v7, s66, v3
    v_and_b32 v8, 7, v1
    v_xor_b32 v7, v7, v8
    v_lshlrev_b32 v7, 4, v7
    s_movk_i32 s67, 1152
    v_and_b32 v9, 3, v4
    v_add_u32 v9, 1, v9
    v_lshrrev_b32 v9, 1, v9
    v_lshlrev_b32 v9, 10, v9
    v_sub_u32 v9, v9, v5
    v_mad_u32_u24 v7, v9, s67, v7
    v_mul_u32_u24 v5, 2304, v5
    v_sub_u32 v5, 1152, v5
    s_bitcmp1_b32 s5, 0
    s_cselect_b32 s92, -1, 1
    s_cselect_b32 s79, 1024, 0
    s_cselect_b32 s34, 4718592, 0
    s_lshl_b32 s92, s92, 7
    s_lshl_b32 s93, s92, 1
    s_lshl_b32 s82, s3, 10
    s_add_u32 s82, s82, 71680
    s_lshl_b32 s68, s3, 1
    s_mov_b32 s94, 0
    s_add_u32 s69, s68, 0
    v_add_u32 v9, s69, v6
    v_and_b32 v9, 511, v9
    v_mad_i32_i24 v100, v9, v5, v7
    s_add_u32 s69, s69, s65
    s_cmp_ge_u32 s69, 512
    s_cselect_b32 s69, 1073741824, 0
    s_add_u32 s94, s94, s69
    s_mov_b32 s95, 0
    s_add_u32 s69, s68, 8
    v_add_u32 v9, s69, v6
    v_and_b32 v9, 511, v9
    v_mad_i32_i24 v101, v9, v5, v7
    s_add_u32 s69, s69, s65
    s_cmp_ge_u32 s69, 512
    s_cselect_b32 s69, 1073741824, 0
    s_add_u32 s95, s95, s69
    s_cmp_ge_u32 s3, 2
    s_cselect_b32 s96, s92, 0
    s_cselect_b32 s69, -4, 16
    s_add_u32 s69, s69, s68
    v_add_u32 v9, s69, v6
    v_and_b32 v9, 511, v9
    v_mad_i32_i24 v102, v9, v5, v7
    s_add_u32 s69, s69, s65
    s_cmp_ge_u32 s69, 512
    s_cselect_b32 s69, 1073741824, 0
    s_add_u32 s96, s96, s69
    s_mov_b32 s97, s92
    s_add_u32 s69, s68, 4
    v_add_u32 v9, s69, v6
    v_and_b32 v9, 511, v9
    v_mad_i32_i24 v103, v9, v5, v7
    s_add_u32 s69, s69, s65
    s_cmp_ge_u32 s69, 512
    s_cselect_b32 s69, 1073741824, 0
    s_add_u32 s97, s97, s69
    s_mov_b32 s98, s92
    s_add_u32 s69, s68, 12
    v_add_u32 v9, s69, v6
    v_and_b32 v9, 511, v9
    v_mad_i32_i24 v104, v9, v5, v7
    s_add_u32 s69, s69, s65
    s_cmp_ge_u32 s69, 512
    s_cselect_b32 s69, 1073741824, 0
    s_add_u32 s98, s98, s69
    s_waitcnt lgkmcnt(0)
    s_mov_b32 s12, s36
    s_mov_b32 s13, s37
    s_mov_b32 s14, 2359296
    s_mov_b32 s15, 0x20000
    s_add_u32 m0, s82, 0
    s_add_u32 s61, s79, s94
    buffer_load_dwordx4 v100, s[12:15], s61 offen lds
    s_add_u32 m0, s82, 4096
    s_add_u32 s61, s79, s95
    buffer_load_dwordx4 v101, s[12:15], s61 offen lds
    s_add_u32 m0, s82, 8192
    s_add_u32 s61, s79, s96
    buffer_load_dwordx4 v102, s[12:15], s61 offen lds
    s_add_u32 m0, s82, 12288
    s_add_u32 s61, s79, s97
    buffer_load_dwordx4 v103, s[12:15], s61 offen lds
    s_add_u32 m0, s82, 16384
    s_add_u32 s61, s79, s98
    buffer_load_dwordx4 v104, s[12:15], s61 offen lds
    s_load_dword s7, s[58:59], 0
    s_cmp_lt_u32 s3, 2
    s_cselect_b32 s20, s42, s44
    s_cselect_b32 s21, s43, s45
    s_mov_b32 s22, 663552
    s_mov_b32 s23, 0x20000
    s_and_b32 s68, s3, 1
    s_lshl_b32 s64, s62, 1
    s_add_u32 s64, s64, s68
    s_mul_i32 s64, s64, 15
    v_add_u32 v9, s64, v1
    s_mul_i32 s64, s60, 73728
    v_lshlrev_b32 v5, 7, v9
    v_add_u32 v6, s64, v5
    v_add_u32 v5, 221184, v5
    v_cmp_gt_u32 vcc, 576, v9
    v_mov_b32 v7, 1073741824
    s_mov_b32 s100, s60
    v_cndmask_b32 v5, v5, v6, vcc
    v_cmp_gt_u32 vcc, 15, v1
    s_mov_b32 s99, s62
    s_sub_u32 s83, s79, s92
    v_cndmask_b32 v132, v7, v5, vcc
    buffer_load_dword v135, v132, s[20:23], 0 offen offset:0
    s_add_u32 s79, s79, s93
    s_add_u32 m0, s82, 20480
    s_add_u32 s61, s79, s94
    buffer_load_dwordx4 v100, s[12:15], s61 offen lds
    s_add_u32 m0, s82, 24576
    s_add_u32 s61, s79, s95
    buffer_load_dwordx4 v101, s[12:15], s61 offen lds
    s_add_u32 m0, s82, 28672
    s_add_u32 s61, s79, s96
    buffer_load_dwordx4 v102, s[12:15], s61 offen lds
    s_mul_i32 s35, s92, 4608
    s_lshl_b32 s68, s5, 5
    s_lshl_b32 s69, s66, 2
    s_add_u32 s68, s68, s69
    v_add_u32 v9, s68, v4
    v_xor_b32 v7, v3, v8
    v_lshlrev_b32 v7, 4, v7
    v_mad_u32_u24 v105, v9, s67, v7
    v_xor_b32 v7, 64, v7
    v_mad_u32_u24 v106, v9, s67, v7
    v_add_u32 v106, 8192, v106
    s_lshl_b32 s60, s3, 11
    s_mov_b32 s8, s48
    s_mov_b32 s9, s49
    s_mov_b32 s10, 5308416
    s_mov_b32 s11, 0x20000
    s_mov_b32 s16, s58
    s_mov_b32 s17, s59
    s_mov_b32 s18, 50331648
    s_mov_b32 s19, 0x20000
    v_lshrrev_b32 v4, 3, v1
    s_lshl_b32 s68, s3, 4
    v_add_u32 v4, s68, v4
    v_and_b32 v5, 1, v3
    v_lshlrev_b32 v5, 1, v5
    v_and_b32 v8, 7, v1
    v_xor_b32 v5, v5, v8
    v_lshlrev_b32 v5, 4, v5
    v_xor_b32 v6, 64, v5
    s_movk_i32 s68, 9216
    v_mad_u32_u24 v10, v4, s68, v5
    v_mad_u32_u24 v11, v4, s68, v6
    v_add_u32 v11, 72704, v11
    v_mad_u32_u24 v12, v4, s67, v5
    v_mad_u32_u24 v13, v4, s67, v6
    v_bfe_u32 v4, v1, 2, 2
    v_and_b32 v5, 3, v1
    v_and_b32 v6, 1, v3
    v_lshlrev_b32 v6, 1, v6
    v_lshrrev_b32 v7, 1, v4
    v_add_u32 v6, v6, v7
    v_xor_b32 v6, s3, v6
    v_lshlrev_b32 v6, 5, v6
    v_lshl_add_u32 v6, v3, 10, v6
    v_lshl_add_u32 v6, v4, 7, v6
    v_lshl_add_u32 v14, v5, 3, v6
    v_add_u32 v15, 0x10000, v14
    v_lshrrev_b32 v4, 1, v2
    v_xor_b32 v4, v4, v3
    v_lshlrev_b32 v4, 4, v4
    v_lshl_add_u32 v4, v2, 7, v4
    v_add_u32 v107, 71680, v4
    v_xor_b32 v108, 64, v107
    v_add_u32 v109, s60, v4
    v_xor_b32 v110, 64, v109
    v_mov_b32 v111, 0xbf803f80
    s_lshl_b32 s68, s5, 2
    s_or_b32 s68, s68, s3
    s_cmp_eq_u32 s68, 2
    s_cselect_b32 s76, 0x00010001, 0
    s_mov_b32 s77, s76
    s_cselect_b32 s69, 1, 0
    s_lshr_b32 s70, s3, 1
    s_cmp_eq_u32 s70, 0
    s_cselect_b32 s71, 1.0, -1.0
    v_mov_b32 v115, s71
    s_cmp_eq_u32 s69, 1
    s_cselect_b32 s72, 16, 0
    v_cmp_gt_u32 vcc, s72, v1
    v_mov_b32 v4, 1.0
    v_and_b32 v5, 1, v1
    v_cndmask_b32 v116, v115, v4, vcc
    s_cmp_eq_u32 s4, 0
    s_cselect_b32 s72, 4, 0
    v_cmp_gt_u32 vcc, s72, v2
    s_cselect_b32 s80, 8, 0
    v_lshlrev_b32 v5, 31, v5
    v_cndmask_b32 v117, v115, 0, vcc
    v_cndmask_b32 v118, v116, 0, vcc
    v_or_b32 v119, v4, v5
    s_cmp_eq_u32 s69, 1
    s_cselect_b32 s80, s80, 0
    s_mov_b32 s81, 0
    v_lshrrev_b32 v4, 2, v2
    v_and_b32 v5, 3, v2
    s_mul_i32 s68, s3, 1792
    s_add_u32 s68, s68, 73728
    v_and_b32 v6, 1, v4
    v_mul_u32_u24 v6, 320, v6
    v_lshrrev_b32 v7, 1, v4
    v_lshl_add_u32 v6, v7, 5, v6
    v_lshl_add_u32 v9, v3, 3, s68
    v_add_u32 v6, v6, v9
    v_add_u32 v7, 640, v6
    v_add_u32 v8, 1344, v9
    v_cmp_eq_u32 vcc, 1, v5
    v_add_u32 v9, 1280, v9
    s_lshl_b32 s71, s70, 1
    v_cndmask_b32 v120, v8, v7, vcc
    v_cmp_eq_u32 vcc, 0, v5
    s_add_u32 s71, s71, 1
    s_nop 0
    v_cndmask_b32 v120, v120, v6, vcc
    v_cndmask_b32 v8, v8, v6, vcc
    v_cmp_eq_u32 vcc, s71, v5
    s_nop 1
    v_cndmask_b32 v8, v8, v7, vcc
    v_cmp_eq_u32 vcc, 2, v5
    s_nop 1
    v_cndmask_b32 v8, v8, v9, vcc
    v_cmp_gt_u32 vcc, s72, v2
    s_cmp_eq_u32 s4, 25
    s_cselect_b32 s75, 1073741824, 0
    v_cndmask_b32 v121, v120, v8, vcc
    s_mul_i32 s68, s5, 26
    s_add_u32 s68, s68, s4
    s_lshl_b32 s68, s68, 7
    s_add_u32 s68, s68, 131072
    v_cmp_gt_u32 vcc, 32, v0
    v_mov_b32 v8, 1073741824
    v_lshl_add_u32 v9, v0, 2, s68
    v_cndmask_b32 v122, v8, v9, vcc
    v_cmp_eq_u32 vcc, 0, v1
    v_lshrrev_b32 v4, 3, v1
    v_mul_u32_u24 v4, 14336, v4
    v_and_b32 v5, 7, v1
    v_lshl_add_u32 v150, v5, 4, v4
    v_cndmask_b32 v126, v8, 0, vcc
    s_mul_i32 s73, s4, 3
    s_and_b32 s73, s73, 7
    s_mov_b32 s101, s73
    s_lshl_b32 s73, s73, 7
    s_lshl_b32 s74, s5, 10
    s_add_u32 s74, s74, s34
    s_add_u32 s62, s73, s74
    s_mul_i32 s6, s4, 2
    s_add_u32 s6, s6, s5
    s_mul_i32 s72, s6, 7282
    s_lshr_b32 s72, s72, 16
    s_mul_i32 s72, s72, 9
    s_sub_u32 s6, s6, s72
    s_add_u32 s72, s6, 1
    s_cmp_eq_u32 s72, 9
    s_cselect_b32 s72, 0, s72
    s_mul_i32 s63, s4, 9
    s_add_u32 s63, s63, s72
    s_lshl_b32 s72, s72, 7
    s_mul_i32 s78, s63, 114688
    s_mul_i32 s63, s3, 3584
    s_add_u32 s78, s78, s63
    s_add_u32 s78, s78, 4194304
    s_mov_b32 s63, 6
    s_waitcnt lgkmcnt(0)
    s_add_u32 s7, s7, 0x9e3779b9
    v_mov_b32 v123, s7
    v_not_b32 v146, s7
    v_not_b32 v147, s7
    v_not_b32 v148, s7
    v_not_b32 v149, s7
    buffer_load_dword v135, v122, s[16:19], 0 offen sc1
    s_add_u32 m0, s82, 32768
    s_add_u32 s61, s79, s97
    buffer_load_dwordx4 v103, s[12:15], s61 offen lds
    s_add_u32 m0, s82, 36864
    s_add_u32 s61, s79, s98
    buffer_load_dwordx4 v104, s[12:15], s61 offen lds
    s_add_u32 s79, s79, s93
    s_add_u32 m0, s82, 40960
    s_add_u32 s61, s79, s94
    buffer_load_dwordx4 v100, s[12:15], s61 offen lds
    s_add_u32 m0, s82, 45056
    s_add_u32 s61, s79, s95
    buffer_load_dwordx4 v101, s[12:15], s61 offen lds
    s_add_u32 m0, s82, 49152
    s_add_u32 s61, s79, s96
    buffer_load_dwordx4 v102, s[12:15], s61 offen lds
    s_add_u32 m0, s82, 53248
    s_add_u32 s61, s79, s97
    buffer_load_dwordx4 v103, s[12:15], s61 offen lds
    s_add_u32 m0, s82, 57344
    s_add_u32 s61, s79, s98
    buffer_load_dwordx4 v104, s[12:15], s61 offen lds
    s_add_u32 s79, s79, s93
    s_add_u32 m0, s82, 61440
    s_add_u32 s61, s79, s94
    buffer_load_dwordx4 v100, s[12:15], s61 offen lds
    s_add_u32 m0, s82, 65536
    s_add_u32 s61, s79, s95
    buffer_load_dwordx4 v101, s[12:15], s61 offen lds
    s_waitcnt vmcnt(14)
    s_barrier
    ds_read_b128 a[0:3], v107 offset:0
    ds_read_b128 a[20:23], v108 offset:0
    ds_read_b128 a[4:7], v107 offset:2048
    ds_read_b128 a[24:27], v108 offset:2048
    ds_read_b128 a[8:11], v107 offset:4096
    ds_read_b128 a[28:31], v108 offset:4096
    ds_read_b128 a[12:15], v107 offset:6144
    ds_read_b128 a[32:35], v108 offset:6144
    ds_read_b128 a[16:19], v107 offset:8192
    ds_read_b128 a[36:39], v108 offset:8192
    s_add_u32 m0, s82, 69632
    s_add_u32 s61, s79, s96
    buffer_load_dwordx4 v102, s[12:15], s61 offen lds
    s_add_u32 m0, s82, 73728
    s_add_u32 s61, s79, s97
    buffer_load_dwordx4 v103, s[12:15], s61 offen lds
    s_add_u32 m0, s82, 77824
    s_add_u32 s61, s79, s98
    buffer_load_dwordx4 v104, s[12:15], s61 offen lds
    ds_read_b128 a[40:43], v107 offset:10240
    ds_read_b128 a[60:63], v108 offset:10240
    ds_read_b128 a[44:47], v107 offset:12288
    ds_read_b128 a[64:67], v108 offset:12288
    ds_read_b128 a[48:51], v107 offset:14336
    ds_read_b128 a[68:71], v108 offset:14336
    ds_read_b128 a[52:55], v107 offset:16384
    ds_read_b128 a[72:75], v108 offset:16384
    ds_read_b128 a[56:59], v107 offset:18432
    ds_read_b128 a[76:79], v108 offset:18432
    s_add_u32 s79, s79, s93
    s_add_u32 m0, s82, 81920
    s_add_u32 s61, s79, s94
    buffer_load_dwordx4 v100, s[12:15], s61 offen lds
    s_add_u32 m0, s82, 86016
    s_add_u32 s61, s79, s95
    buffer_load_dwordx4 v101, s[12:15], s61 offen lds
    s_cmp_lt_u32 s3, 2
    s_cbranch_scc0 L_nox22
    s_add_u32 m0, s82, 90112
    s_add_u32 s61, s79, s96
    buffer_load_dwordx4 v102, s[12:15], s61 offen lds
L_nox22:
    s_waitcnt vmcnt(12)
    s_barrier
    s_add_u32 m0, s60, 0
    s_add_u32 s83, s83, s92
    buffer_load_dwordx4 v105, s[20:23], s83 offen lds
    buffer_load_dwordx4 v106, s[20:23], s83 offen offset:1024 lds
    ds_read_b128 a[80:83], v107 offset:20480
    ds_read_b128 a[100:103], v108 offset:20480
    ds_read_b128 a[84:87], v107 offset:22528
    ds_read_b128 a[104:107], v108 offset:22528
    ds_read_b128 a[88:91], v107 offset:24576
    ds_read_b128 a[108:111], v108 offset:24576
    ds_read_b128 a[92:95], v107 offset:26624
    ds_read_b128 a[112:115], v108 offset:26624
    ds_read_b128 a[96:99], v107 offset:28672
    ds_read_b128 a[116:119], v108 offset:28672
    s_add_u32 m0, s60, 8192
    s_add_u32 s83, s83, s92
    buffer_load_dwordx4 v105, s[20:23], s83 offen lds
    buffer_load_dwordx4 v106, s[20:23], s83 offen offset:1024 lds
    s_add_u32 m0, s60, 16384
    s_add_u32 s83, s83, s92
    buffer_load_dwordx4 v105, s[20:23], s83 offen lds
    buffer_load_dwordx4 v106, s[20:23], s83 offen offset:1024 lds
    ds_read_b128 a[120:123], v107 offset:30720
    ds_read_b128 a[140:143], v108 offset:30720
    ds_read_b128 a[124:127], v107 offset:32768
    ds_read_b128 a[144:147], v108 offset:32768
    ds_read_b128 a[128:131], v107 offset:34816
    ds_read_b128 a[148:151], v108 offset:34816
    ds_read_b128 a[132:135], v107 offset:36864
    ds_read_b128 a[152:155], v108 offset:36864
    ds_read_b128 a[136:139], v107 offset:38912
    ds_read_b128 a[156:159], v108 offset:38912
    s_add_u32 m0, s60, 24576
    s_add_u32 s83, s83, s92
    buffer_load_dwordx4 v105, s[20:23], s83 offen lds
    buffer_load_dwordx4 v106, s[20:23], s83 offen offset:1024 lds
    s_add_u32 m0, s60, 32768
    s_add_u32 s83, s83, s92
    buffer_load_dwordx4 v105, s[20:23], s83 offen lds
    buffer_load_dwordx4 v106, s[20:23], s83 offen offset:1024 lds
    s_waitcnt vmcnt(8) lgkmcnt(15)
    s_barrier
    ds_read_b128 v[56:59], v109 offset:0
    ds_read_b128 v[60:63], v110 offset:0
    s_add_u32 m0, s60, 40960
    s_add_u32 s83, s83, s92
    buffer_load_dwordx4 v105, s[20:23], s83 offen lds
    buffer_load_dwordx4 v106, s[20:23], s83 offen offset:1024 lds
    s_waitcnt lgkmcnt(0)
    v_cndmask_b32 v56, v56, v111, s[76:77]
    v_cndmask_b32 v57, v57, v111, s[76:77]
    v_cndmask_b32 v58, v58, v111, s[76:77]
    v_cndmask_b32 v59, v59, v111, s[76:77]
    v_cndmask_b32 v60, v60, v111, s[76:77]
    v_cndmask_b32 v61, v61, v111, s[76:77]
    v_cndmask_b32 v62, v62, v111, s[76:77]
    v_cndmask_b32 v63, v63, v111, s[76:77]
    s_nop 1
    v_mfma_f32_16x16x32_bf16 v[16:19], v[56:59], a[0:3], 0
    s_waitcnt vmcnt(8)
    ds_read_b128 v[64:67], v109 offset:8192
    v_mfma_f32_16x16x32_bf16 v[20:23], v[56:59], a[4:7], 0
    ds_read_b128 v[68:71], v110 offset:8192
    v_add_u32 v107, 40960, v107
    v_add_u32 v108, 40960, v108
    v_mfma_f32_16x16x32_bf16 v[24:27], v[56:59], a[8:11], 0
    ds_read_b128 a[160:163], v107 offset:0
    s_add_u32 m0, s60, 49152
    s_add_u32 s83, s83, s92
    buffer_load_dwordx4 v105, s[20:23], s83 offen lds
    v_mfma_f32_16x16x32_bf16 v[28:31], v[56:59], a[12:15], 0
    ds_read_b128 a[180:183], v108 offset:0
    ds_read_b128 a[164:167], v107 offset:2048
    buffer_load_dwordx4 v106, s[20:23], s83 offen offset:1024 lds
    v_mfma_f32_16x16x32_bf16 v[32:35], v[56:59], a[16:19], 0
    ds_read_b128 a[184:187], v108 offset:2048
    s_add_u32 m0, s60, 57344
    s_add_u32 s83, s83, s92
    buffer_load_dwordx4 v105, s[20:23], s83 offen lds
    v_mfma_f32_16x16x32_bf16 v[16:19], v[60:63], a[20:23], v[16:19]
    ds_read_b128 a[168:171], v107 offset:4096
    ds_read_b128 a[188:191], v108 offset:4096
    buffer_load_dwordx4 v106, s[20:23], s83 offen offset:1024 lds
    v_mfma_f32_16x16x32_bf16 v[20:23], v[60:63], a[24:27], v[20:23]
    s_waitcnt lgkmcnt(6)
    v_cndmask_b32 v64, v64, v111, s[76:77]
    v_cndmask_b32 v65, v65, v111, s[76:77]
    v_cndmask_b32 v66, v66, v111, s[76:77]
    v_mfma_f32_16x16x32_bf16 v[24:27], v[60:63], a[28:31], v[24:27]
    ds_read_b128 a[172:175], v107 offset:6144
    v_cndmask_b32 v67, v67, v111, s[76:77]
    v_cndmask_b32 v68, v68, v111, s[76:77]
    v_cndmask_b32 v69, v69, v111, s[76:77]
    v_mfma_f32_16x16x32_bf16 v[28:31], v[60:63], a[32:35], v[28:31]
    ds_read_b128 a[192:195], v108 offset:6144
    ds_read_b128 a[176:179], v107 offset:8192
    v_cndmask_b32 v70, v70, v111, s[76:77]
    v_cndmask_b32 v71, v71, v111, s[76:77]
    v_mfma_f32_16x16x32_bf16 v[32:35], v[60:63], a[36:39], v[32:35]
    ds_read_b128 a[196:199], v108 offset:8192
    s_nop 0
    v_mfma_f32_16x16x32_bf16 v[16:19], v[64:67], a[40:43], v[16:19]
    s_waitcnt vmcnt(10)
    ds_read_b128 v[72:75], v109 offset:16384
    v_mfma_f32_16x16x32_bf16 v[20:23], v[64:67], a[44:47], v[20:23]
    ds_read_b128 v[76:79], v110 offset:16384
    ds_read_b128 a[200:203], v107 offset:10240
    ds_read_b128 a[220:223], v108 offset:10240
    v_mfma_f32_16x16x32_bf16 v[24:27], v[64:67], a[48:51], v[24:27]
    ds_read_b128 a[204:207], v107 offset:12288
    s_add_u32 m0, s60, 65536
    s_add_u32 s83, s83, s92
    buffer_load_dwordx4 v105, s[20:23], s83 offen lds
    v_mfma_f32_16x16x32_bf16 v[28:31], v[64:67], a[52:55], v[28:31]
    ds_read_b128 a[224:227], v108 offset:12288
    buffer_load_dwordx4 v106, s[20:23], s83 offen offset:1024 lds
    v_mfma_f32_16x16x32_bf16 v[32:35], v[64:67], a[56:59], v[32:35]
    ds_read_b128 a[208:211], v107 offset:14336
    s_add_u32 m0, s60, 0
    s_mov_b32 s61, s62
    buffer_load_dwordx4 v10, s[8:11], s61 offen offset:0 lds
    v_mfma_f32_16x16x32_bf16 v[16:19], v[68:71], a[60:63], v[16:19]
    ds_read_b128 a[228:231], v108 offset:14336
    ds_read_b128 a[212:215], v107 offset:16384
    buffer_load_dwordx4 v11, s[8:11], s61 offen offset:1024 lds
    v_mfma_f32_16x16x32_bf16 v[20:23], v[68:71], a[64:67], v[20:23]
    s_waitcnt lgkmcnt(7)
    v_cndmask_b32 v72, v72, v111, s[76:77]
    v_cndmask_b32 v73, v73, v111, s[76:77]
    v_cndmask_b32 v74, v74, v111, s[76:77]
    v_mfma_f32_16x16x32_bf16 v[24:27], v[68:71], a[68:71], v[24:27]
    ds_read_b128 a[232:235], v108 offset:16384
    v_cndmask_b32 v75, v75, v111, s[76:77]
    v_cndmask_b32 v76, v76, v111, s[76:77]
    v_cndmask_b32 v77, v77, v111, s[76:77]
    v_mfma_f32_16x16x32_bf16 v[28:31], v[68:71], a[72:75], v[28:31]
    ds_read_b128 a[216:219], v107 offset:18432
    v_cndmask_b32 v78, v78, v111, s[76:77]
    v_cndmask_b32 v79, v79, v111, s[76:77]
    v_mfma_f32_16x16x32_bf16 v[32:35], v[68:71], a[76:79], v[32:35]
    ds_read_b128 a[236:239], v108 offset:18432
    s_nop 0
    v_mfma_f32_16x16x32_bf16 v[16:19], v[72:75], a[80:83], v[16:19]
    s_waitcnt vmcnt(12)
    ds_read_b128 v[56:59], v109 offset:24576
    v_mfma_f32_16x16x32_bf16 v[20:23], v[72:75], a[84:87], v[20:23]
    ds_read_b128 v[60:63], v110 offset:24576
    ds_read_b128 a[240:243], v107 offset:20480
    ds_read_b128 v[156:159], v108 offset:20480
    v_mfma_f32_16x16x32_bf16 v[24:27], v[72:75], a[88:91], v[24:27]
    ds_read_b128 a[244:247], v107 offset:22528
    s_add_u32 m0, s60, 8192
    s_add_u32 s61, s61, s35
    buffer_load_dwordx4 v10, s[8:11], s61 offen offset:0 lds
    v_mfma_f32_16x16x32_bf16 v[28:31], v[72:75], a[92:95], v[28:31]
    ds_read_b128 v[160:163], v108 offset:22528
    buffer_load_dwordx4 v11, s[8:11], s61 offen offset:1024 lds
    v_mfma_f32_16x16x32_bf16 v[32:35], v[72:75], a[96:99], v[32:35]
    ds_read_b128 a[248:251], v107 offset:24576
    s_add_u32 m0, s60, 16384
    s_add_u32 s61, s61, s35
    buffer_load_dwordx4 v10, s[8:11], s61 offen offset:0 lds
    v_mfma_f32_16x16x32_bf16 v[16:19], v[76:79], a[100:103], v[16:19]
    ds_read_b128 v[164:167], v108 offset:24576
    ds_read_b128 a[252:255], v107 offset:26624
    v_mfma_f32_16x16x32_bf16 v[20:23], v[76:79], a[104:107], v[20:23]
    s_waitcnt lgkmcnt(7)
    v_cndmask_b32 v56, v56, v111, s[76:77]
    v_cndmask_b32 v57, v57, v111, s[76:77]
    v_cndmask_b32 v58, v58, v111, s[76:77]
    v_mfma_f32_16x16x32_bf16 v[24:27], v[76:79], a[108:111], v[24:27]
    ds_read_b128 v[168:171], v108 offset:26624
    v_cndmask_b32 v59, v59, v111, s[76:77]
    v_cndmask_b32 v60, v60, v111, s[76:77]
    v_cndmask_b32 v61, v61, v111, s[76:77]
    v_mfma_f32_16x16x32_bf16 v[28:31], v[76:79], a[112:115], v[28:31]
    ds_read_b128 v[152:155], v107 offset:28672
    v_cndmask_b32 v62, v62, v111, s[76:77]
    v_cndmask_b32 v63, v63, v111, s[76:77]
    v_mfma_f32_16x16x32_bf16 v[32:35], v[76:79], a[116:119], v[32:35]
    ds_read_b128 v[172:175], v108 offset:28672
    s_nop 0
    v_mfma_f32_16x16x32_bf16 v[16:19], v[56:59], a[120:123], v[16:19]
    s_waitcnt vmcnt(13)
    v_add_u32 v109, 32768, v109
    v_add_u32 v110, 32768, v110
    v_mfma_f32_16x16x32_bf16 v[20:23], v[56:59], a[124:127], v[20:23]
    ds_read_b128 v[64:67], v109 offset:0
    ds_read_b128 v[68:71], v110 offset:0
    ds_read_b128 v[176:179], v107 offset:30720
    ds_read_b128 v[196:199], v108 offset:30720
    v_mfma_f32_16x16x32_bf16 v[24:27], v[56:59], a[128:131], v[24:27]
    ds_read_b128 v[180:183], v107 offset:32768
    buffer_load_dwordx4 v11, s[8:11], s61 offen offset:1024 lds
    v_mfma_f32_16x16x32_bf16 v[28:31], v[56:59], a[132:135], v[28:31]
    ds_read_b128 v[200:203], v108 offset:32768
    s_add_u32 m0, s60, 24576
    s_add_u32 s61, s61, s35
    buffer_load_dwordx4 v10, s[8:11], s61 offen offset:0 lds
    v_mfma_f32_16x16x32_bf16 v[32:35], v[56:59], a[136:139], v[32:35]
    ds_read_b128 v[184:187], v107 offset:34816
    buffer_load_dwordx4 v11, s[8:11], s61 offen offset:1024 lds
    v_mfma_f32_16x16x32_bf16 v[16:19], v[60:63], a[140:143], v[16:19]
    ds_read_b128 v[204:207], v108 offset:34816
    ds_read_b128 v[188:191], v107 offset:36864
    v_mfma_f32_16x16x32_bf16 v[20:23], v[60:63], a[144:147], v[20:23]
    s_waitcnt lgkmcnt(7)
    v_cndmask_b32 v64, v64, v111, s[76:77]
    v_cndmask_b32 v65, v65, v111, s[76:77]
    v_cndmask_b32 v66, v66, v111, s[76:77]
    v_mfma_f32_16x16x32_bf16 v[24:27], v[60:63], a[148:151], v[24:27]
    ds_read_b128 v[208:211], v108 offset:36864
    v_cndmask_b32 v67, v67, v111, s[76:77]
    v_cndmask_b32 v68, v68, v111, s[76:77]
    v_cndmask_b32 v69, v69, v111, s[76:77]
    v_mfma_f32_16x16x32_bf16 v[28:31], v[60:63], a[152:155], v[28:31]
    ds_read_b128 v[192:195], v107 offset:38912
    v_cndmask_b32 v70, v70, v111, s[76:77]
    v_cndmask_b32 v71, v71, v111, s[76:77]
    v_mfma_f32_16x16x32_bf16 v[32:35], v[60:63], a[156:159], v[32:35]
    ds_read_b128 v[212:215], v108 offset:38912
    s_nop 0
    v_mfma_f32_16x16x32_bf16 v[16:19], v[64:67], a[160:163], v[16:19]
    s_waitcnt vmcnt(14)
    ds_read_b128 v[72:75], v109 offset:8192
    v_mfma_f32_16x16x32_bf16 v[20:23], v[64:67], a[164:167], v[20:23]
    ds_read_b128 v[76:79], v110 offset:8192
    ds_read_b128 v[216:219], v107 offset:40960
    ds_read_b128 v[236:239], v108 offset:40960
    v_mfma_f32_16x16x32_bf16 v[24:27], v[64:67], a[168:171], v[24:27]
    ds_read_b128 v[220:223], v107 offset:43008
    s_add_u32 m0, s60, 32768
    s_add_u32 s61, s61, s35
    buffer_load_dwordx4 v10, s[8:11], s61 offen offset:0 lds
    v_mfma_f32_16x16x32_bf16 v[28:31], v[64:67], a[172:175], v[28:31]
    ds_read_b128 v[240:243], v108 offset:43008
    v_mfma_f32_16x16x32_bf16 v[32:35], v[64:67], a[176:179], v[32:35]
    ds_read_b128 v[224:227], v107 offset:45056
    buffer_load_dwordx4 v11, s[8:11], s61 offen offset:1024 lds
    v_mfma_f32_16x16x32_bf16 v[16:19], v[68:71], a[180:183], v[16:19]
    ds_read_b128 v[244:247], v108 offset:45056
    ds_read_b128 v[228:231], v107 offset:47104
    v_mfma_f32_16x16x32_bf16 v[20:23], v[68:71], a[184:187], v[20:23]
    s_waitcnt lgkmcnt(7)
    v_cndmask_b32 v72, v72, v111, s[76:77]
    v_cndmask_b32 v73, v73, v111, s[76:77]
    v_cndmask_b32 v74, v74, v111, s[76:77]
    v_mfma_f32_16x16x32_bf16 v[24:27], v[68:71], a[188:191], v[24:27]
    ds_read_b128 v[248:251], v108 offset:47104
    v_cndmask_b32 v75, v75, v111, s[76:77]
    v_cndmask_b32 v76, v76, v111, s[76:77]
    v_cndmask_b32 v77, v77, v111, s[76:77]
    v_mfma_f32_16x16x32_bf16 v[28:31], v[68:71], a[192:195], v[28:31]
    ds_read_b128 v[232:235], v107 offset:49152
    v_cndmask_b32 v78, v78, v111, s[76:77]
    v_cndmask_b32 v79, v79, v111, s[76:77]
    v_mfma_f32_16x16x32_bf16 v[32:35], v[68:71], a[196:199], v[32:35]
    ds_read_b128 v[252:255], v108 offset:49152
    s_nop 0
    v_mfma_f32_16x16x32_bf16 v[16:19], v[72:75], a[200:203], v[16:19]
    s_waitcnt vmcnt(14)
    ds_read_b128 v[56:59], v109 offset:16384
    v_mfma_f32_16x16x32_bf16 v[20:23], v[72:75], a[204:207], v[20:23]
    ds_read_b128 v[60:63], v110 offset:16384
    s_lshr_b32 s68, s5, 1
    s_lshl_b32 s68, s68, 17
    s_lshr_b32 s70, s3, 1
    v_mfma_f32_16x16x32_bf16 v[24:27], v[72:75], a[208:211], v[24:27]
    s_add_u32 m0, s60, 40960
    s_add_u32 s61, s61, s35
    buffer_load_dwordx4 v10, s[8:11], s61 offen offset:0 lds
    v_mfma_f32_16x16x32_bf16 v[28:31], v[72:75], a[212:215], v[28:31]
    s_lshl_b32 s71, s70, 16
    s_add_u32 s68, s68, s71
    s_mul_i32 s71, s4, 320
    v_mfma_f32_16x16x32_bf16 v[32:35], v[72:75], a[216:219], v[32:35]
    buffer_load_dwordx4 v11, s[8:11], s61 offen offset:1024 lds
    v_mfma_f32_16x16x32_bf16 v[16:19], v[76:79], a[220:223], v[16:19]
    s_add_u32 s68, s68, s71
    s_and_b32 s71, s5, 1
    s_lshl_b32 s71, s71, 14
    v_mfma_f32_16x16x32_bf16 v[20:23], v[76:79], a[224:227], v[20:23]
    s_waitcnt lgkmcnt(0)
    v_cndmask_b32 v56, v56, v111, s[76:77]
    v_cndmask_b32 v57, v57, v111, s[76:77]
    v_cndmask_b32 v58, v58, v111, s[76:77]
    v_mfma_f32_16x16x32_bf16 v[24:27], v[76:79], a[228:231], v[24:27]
    v_cndmask_b32 v59, v59, v111, s[76:77]
    v_cndmask_b32 v60, v60, v111, s[76:77]
    v_cndmask_b32 v61, v61, v111, s[76:77]
    v_mfma_f32_16x16x32_bf16 v[28:31], v[76:79], a[232:235], v[28:31]
    v_cndmask_b32 v62, v62, v111, s[76:77]
    v_cndmask_b32 v63, v63, v111, s[76:77]
    v_mfma_f32_16x16x32_bf16 v[32:35], v[76:79], a[236:239], v[32:35]
    s_add_u32 s68, s68, s71
    s_and_b32 s71, s3, 1
    s_lshl_b32 s69, s71, 13
    s_add_u32 s68, s68, s69
    s_add_u32 s68, s68, 1048576
    s_lshl_b32 s71, s71, 5
    s_nop 0
    v_mfma_f32_16x16x32_bf16 v[16:19], v[56:59], a[240:243], v[16:19]
    s_waitcnt vmcnt(14)
    ds_read_b128 v[64:67], v109 offset:24576
    v_mfma_f32_16x16x32_bf16 v[20:23], v[56:59], a[244:247], v[20:23]
    ds_read_b128 v[68:71], v110 offset:24576
    s_lshl_b32 s69, s5, 6
    s_add_u32 s69, s69, s71
    s_lshl_b32 s70, s70, 10
    v_mfma_f32_16x16x32_bf16 v[24:27], v[56:59], a[248:251], v[24:27]
    s_add_u32 m0, s60, 49152
    s_add_u32 s61, s61, s35
    buffer_load_dwordx4 v10, s[8:11], s61 offen offset:0 lds
    v_mfma_f32_16x16x32_bf16 v[28:31], v[56:59], a[252:255], v[28:31]
    s_add_u32 s69, s69, s70
    s_add_u32 s69, s69, 77504
    v_mul_u32_u24 v4, 13, v1
    v_mfma_f32_16x16x32_bf16 v[32:35], v[56:59], v[152:155], v[32:35]
    buffer_load_dwordx4 v11, s[8:11], s61 offen offset:1024 lds
    v_mfma_f32_16x16x32_bf16 v[16:19], v[60:63], v[156:159], v[16:19]
    v_lshrrev_b32 v4, 8, v4
    v_mul_u32_u24 v5, 20, v4
    v_sub_u32 v5, v1, v5
    v_mfma_f32_16x16x32_bf16 v[20:23], v[60:63], v[160:163], v[20:23]
    s_waitcnt lgkmcnt(0)
    v_cndmask_b32 v64, v64, v111, s[76:77]
    v_cndmask_b32 v65, v65, v111, s[76:77]
    v_cndmask_b32 v66, v66, v111, s[76:77]
    v_mfma_f32_16x16x32_bf16 v[24:27], v[60:63], v[164:167], v[24:27]
    v_cndmask_b32 v67, v67, v111, s[76:77]
    v_cndmask_b32 v68, v68, v111, s[76:77]
    v_cndmask_b32 v69, v69, v111, s[76:77]
    v_mfma_f32_16x16x32_bf16 v[28:31], v[60:63], v[168:171], v[28:31]
    v_cndmask_b32 v70, v70, v111, s[76:77]
    v_cndmask_b32 v71, v71, v111, s[76:77]
    v_mfma_f32_16x16x32_bf16 v[32:35], v[60:63], v[172:175], v[32:35]
    v_and_b32 v6, 1, v4
    v_lshlrev_b32 v6, 15, v6
    v_lshrrev_b32 v7, 1, v4
    v_mul_u32_u24 v7, 655360, v7
    v_lshl_add_u32 v6, v5, 4, v6
    v_add3_u32 v6, v6, v7, s68
    s_cmp_eq_u32 s4, 25
    s_cselect_b32 s70, 12, 20
    s_nop 0
    v_mfma_f32_16x16x32_bf16 v[16:19], v[64:67], v[176:179], v[16:19]
    s_waitcnt vmcnt(14)
    ds_read_b128 v[72:75], v109 offset:32768
    v_mfma_f32_16x16x32_bf16 v[20:23], v[64:67], v[180:183], v[20:23]
    ds_read_b128 v[76:79], v110 offset:32768
    v_cmp_gt_u32 vcc, s70, v5
    v_mov_b32 v8, 1073741824
    v_lshlrev_b32 v7, 4, v1
    v_cndmask_b32 v6, v8, v6, vcc
    v_mfma_f32_16x16x32_bf16 v[24:27], v[64:67], v[184:187], v[24:27]
    s_add_u32 m0, s60, 57344
    s_add_u32 s61, s61, s35
    buffer_load_dwordx4 v10, s[8:11], s61 offen offset:0 lds
    v_mfma_f32_16x16x32_bf16 v[28:31], v[64:67], v[188:191], v[28:31]
    v_cmp_gt_u32 vcc, 60, v1
    s_add_u32 s68, s68, 688128
    v_add_u32 v9, s68, v7
    v_cndmask_b32 v101, v8, v6, vcc
    v_mfma_f32_16x16x32_bf16 v[32:35], v[64:67], v[192:195], v[32:35]
    v_mfma_f32_16x16x32_bf16 v[16:19], v[68:71], v[196:199], v[16:19]
    v_cmp_gt_u32 vcc, s70, v1
    v_add_u32 v6, s69, v7
    v_lshrrev_b32 v5, 1, v1
    v_cndmask_b32 v9, v8, v9, vcc
    v_mfma_f32_16x16x32_bf16 v[20:23], v[68:71], v[200:203], v[20:23]
    s_waitcnt lgkmcnt(0)
    v_cndmask_b32 v72, v72, v111, s[76:77]
    v_cndmask_b32 v73, v73, v111, s[76:77]
    v_cndmask_b32 v74, v74, v111, s[76:77]
    v_mfma_f32_16x16x32_bf16 v[24:27], v[68:71], v[204:207], v[24:27]
    v_cndmask_b32 v75, v75, v111, s[76:77]
    v_cndmask_b32 v76, v76, v111, s[76:77]
    v_cndmask_b32 v77, v77, v111, s[76:77]
    v_mfma_f32_16x16x32_bf16 v[28:31], v[68:71], v[208:211], v[28:31]
    v_cndmask_b32 v78, v78, v111, s[76:77]
    v_cndmask_b32 v79, v79, v111, s[76:77]
    v_mfma_f32_16x16x32_bf16 v[32:35], v[68:71], v[212:215], v[32:35]
    s_cmp_eq_u32 s4, 0
    s_cselect_b32 s70, 10, -1
    v_cmp_eq_u32 vcc, s70, v5
    s_mul_i32 s68, s3, 1792
    s_add_u32 s68, s68, 73728
    v_add_u32 v100, s68, v7
    v_cndmask_b32 v102, v9, v6, vcc
    s_nop 0
    v_mfma_f32_16x16x32_bf16 v[16:19], v[72:75], v[216:219], v[16:19]
    s_waitcnt vmcnt(9)
    s_barrier
    v_mfma_f32_16x16x32_bf16 v[20:23], v[72:75], v[220:223], v[20:23]
    ds_read_b64_tr_b16 v[56:57], v14 offset:0
    v_mfma_f32_16x16x32_bf16 v[24:27], v[72:75], v[224:227], v[24:27]
    ds_read_b64_tr_b16 v[58:59], v14 offset:512
    v_mfma_f32_16x16x32_bf16 v[28:31], v[72:75], v[228:231], v[28:31]
    ds_read_b64_tr_b16 v[60:61], v14 offset:4096
    v_mfma_f32_16x16x32_bf16 v[32:35], v[72:75], v[232:235], v[32:35]
    ds_read_b64_tr_b16 v[62:63], v14 offset:4608
    v_mfma_f32_16x16x32_bf16 v[36:39], v[76:79], v[236:239], v[16:19]
    ds_read_b64_tr_b16 v[64:65], v14 offset:8192
    v_mfma_f32_16x16x32_bf16 v[40:43], v[76:79], v[240:243], v[20:23]
    ds_read_b64_tr_b16 v[66:67], v14 offset:8704
    v_mfma_f32_16x16x32_bf16 v[44:47], v[76:79], v[244:247], v[24:27]
    v_mfma_f32_16x16x32_bf16 v[48:51], v[76:79], v[248:251], v[28:31]
    v_mfma_f32_16x16x32_bf16 v[52:55], v[76:79], v[252:255], v[32:35]
    s_waitcnt lgkmcnt(0)
    v_mfma_f32_16x16x32_bf16 v[16:19], v[56:59], a[0:3], 0
    v_mfma_f32_16x16x32_bf16 v[20:23], v[56:59], a[4:7], 0
    ds_read_b64_tr_b16 v[68:69], v14 offset:12288
    v_mfma_f32_16x16x32_bf16 v[24:27], v[56:59], a[8:11], 0
    ds_read_b64_tr_b16 v[70:71], v14 offset:12800
    v_mfma_f32_16x16x32_bf16 v[28:31], v[56:59], a[12:15], 0
    buffer_load_dwordx4 v11, s[8:11], s61 offen offset:1024 lds
    v_fmac_f32_dpp v36, v36, v118 quad_perm:[3,2,1,0] row_mask:0xf bank_mask:0xf
    v_fmac_f32_dpp v37, v37, v117 quad_perm:[3,2,1,0] row_mask:0xf bank_mask:0xf
    v_fmac_f32_dpp v38, v38, v117 quad_perm:[3,2,1,0] row_mask:0xf bank_mask:0xf
    v_mfma_f32_16x16x32_bf16 v[32:35], v[56:59], a[16:19], 0
    ds_read_b64_tr_b16 v[72:73], v14 offset:16384
    v_fmac_f32_dpp v39, v39, v117 quad_perm:[3,2,1,0] row_mask:0xf bank_mask:0xf
    v_fmac_f32_dpp v36, v36, v119 quad_perm:[1,0,3,2] row_mask:0xf bank_mask:0xf
    v_mfma_f32_16x16x32_bf16 v[16:19], v[60:63], a[20:23], v[16:19]
    ds_read_b64_tr_b16 v[74:75], v14 offset:16896
    v_fmac_f32_dpp v37, v37, v119 quad_perm:[1,0,3,2] row_mask:0xf bank_mask:0xf
    v_fmac_f32_dpp v38, v38, v119 quad_perm:[1,0,3,2] row_mask:0xf bank_mask:0xf
    v_fmac_f32_dpp v39, v39, v119 quad_perm:[1,0,3,2] row_mask:0xf bank_mask:0xf
    v_mfma_f32_16x16x32_bf16 v[20:23], v[60:63], a[24:27], v[20:23]
    ds_read_b64_tr_b16 v[76:77], v14 offset:20480
    s_add_u32 m0, s60, 65536
    v_mov_b32_dpp v98, v36 quad_perm:[0,1,2,1] row_mask:0xf bank_mask:0xf
    v_cndmask_b32 v36, v36, v98, s[80:81]
    v_mfma_f32_16x16x32_bf16 v[24:27], v[60:63], a[28:31], v[24:27]
    ds_read_b64_tr_b16 v[78:79], v14 offset:20992
    s_add_u32 s61, s61, s35
    v_cvt_pk_bf16_f32 v136, v36, v37
    v_cvt_pk_bf16_f32 v137, v38, v39
    v_mfma_f32_16x16x32_bf16 v[28:31], v[60:63], a[32:35], v[28:31]
    buffer_load_dwordx4 v10, s[8:11], s61 offen offset:0 lds
    v_fmac_f32_dpp v40, v40, v116 quad_perm:[3,2,1,0] row_mask:0xf bank_mask:0xf
    v_fmac_f32_dpp v41, v41, v115 quad_perm:[3,2,1,0] row_mask:0xf bank_mask:0xf
    v_fmac_f32_dpp v42, v42, v115 quad_perm:[3,2,1,0] row_mask:0xf bank_mask:0xf
    v_mfma_f32_16x16x32_bf16 v[32:35], v[60:63], a[36:39], v[32:35]
    ds_write_b64 v121, v[136:137] offset:0
    v_fmac_f32_dpp v43, v43, v115 quad_perm:[3,2,1,0] row_mask:0xf bank_mask:0xf
    v_fmac_f32_dpp v40, v40, v119 quad_perm:[1,0,3,2] row_mask:0xf bank_mask:0xf
    v_mfma_f32_16x16x32_bf16 v[16:19], v[64:67], a[40:43], v[16:19]
    v_fmac_f32_dpp v41, v41, v119 quad_perm:[1,0,3,2] row_mask:0xf bank_mask:0xf
    v_fmac_f32_dpp v42, v42, v119 quad_perm:[1,0,3,2] row_mask:0xf bank_mask:0xf
    v_fmac_f32_dpp v43, v43, v119 quad_perm:[1,0,3,2] row_mask:0xf bank_mask:0xf
    v_mfma_f32_16x16x32_bf16 v[20:23], v[64:67], a[44:47], v[20:23]
    s_add_u32 s73, s73, 128
    s_and_b32 s73, s73, 0x380
    v_cvt_pk_bf16_f32 v138, v40, v41
    v_cvt_pk_bf16_f32 v139, v42, v43
    v_mfma_f32_16x16x32_bf16 v[24:27], v[64:67], a[48:51], v[24:27]
    s_add_u32 s62, s73, s74
    ds_write_b64 v120, v[138:139] offset:64
    v_fmac_f32_dpp v44, v44, v116 quad_perm:[3,2,1,0] row_mask:0xf bank_mask:0xf
    v_fmac_f32_dpp v45, v45, v115 quad_perm:[3,2,1,0] row_mask:0xf bank_mask:0xf
    v_mfma_f32_16x16x32_bf16 v[28:31], v[64:67], a[52:55], v[28:31]
    buffer_load_dwordx4 v11, s[8:11], s61 offen offset:1024 lds
    v_fmac_f32_dpp v46, v46, v115 quad_perm:[3,2,1,0] row_mask:0xf bank_mask:0xf
    v_fmac_f32_dpp v47, v47, v115 quad_perm:[3,2,1,0] row_mask:0xf bank_mask:0xf
    v_mfma_f32_16x16x32_bf16 v[32:35], v[64:67], a[56:59], v[32:35]
    v_fmac_f32_dpp v44, v44, v119 quad_perm:[1,0,3,2] row_mask:0xf bank_mask:0xf
    v_fmac_f32_dpp v45, v45, v119 quad_perm:[1,0,3,2] row_mask:0xf bank_mask:0xf
    s_waitcnt lgkmcnt(2)
    v_mfma_f32_16x16x32_bf16 v[16:19], v[68:71], a[60:63], v[16:19]
    s_waitcnt vmcnt(6)
    s_barrier
    v_mfma_f32_16x16x32_bf16 v[20:23], v[68:71], a[64:67], v[20:23]
    ds_read_b64_tr_b16 v[56:57], v14 offset:24576
    s_add_u32 m0, s60, 0
    v_fmac_f32_dpp v46, v46, v119 quad_perm:[1,0,3,2] row_mask:0xf bank_mask:0xf
    v_fmac_f32_dpp v47, v47, v119 quad_perm:[1,0,3,2] row_mask:0xf bank_mask:0xf
    v_mfma_f32_16x16x32_bf16 v[24:27], v[68:71], a[68:71], v[24:27]
    ds_read_b64_tr_b16 v[58:59], v14 offset:25088
    s_mov_b32 s61, s62
    v_cvt_pk_bf16_f32 v140, v44, v45
    v_cvt_pk_bf16_f32 v141, v46, v47
    v_mfma_f32_16x16x32_bf16 v[28:31], v[68:71], a[72:75], v[28:31]
    buffer_load_dwordx4 v10, s[8:11], s61 offen offset:0 lds
    v_fmac_f32_dpp v48, v48, v116 quad_perm:[3,2,1,0] row_mask:0xf bank_mask:0xf
    v_fmac_f32_dpp v49, v49, v115 quad_perm:[3,2,1,0] row_mask:0xf bank_mask:0xf
    v_mfma_f32_16x16x32_bf16 v[32:35], v[68:71], a[76:79], v[32:35]
    ds_read_b64_tr_b16 v[60:61], v14 offset:28672
    v_fmac_f32_dpp v50, v50, v115 quad_perm:[3,2,1,0] row_mask:0xf bank_mask:0xf
    v_mfma_f32_16x16x32_bf16 v[16:19], v[72:75], a[80:83], v[16:19]
    ds_read_b64_tr_b16 v[62:63], v14 offset:29184
    v_fmac_f32_dpp v51, v51, v115 quad_perm:[3,2,1,0] row_mask:0xf bank_mask:0xf
    v_fmac_f32_dpp v48, v48, v119 quad_perm:[1,0,3,2] row_mask:0xf bank_mask:0xf
    v_mfma_f32_16x16x32_bf16 v[20:23], v[72:75], a[84:87], v[20:23]
    ds_read_b64_tr_b16 v[64:65], v14 offset:32768
    v_fmac_f32_dpp v49, v49, v119 quad_perm:[1,0,3,2] row_mask:0xf bank_mask:0xf
    v_fmac_f32_dpp v50, v50, v119 quad_perm:[1,0,3,2] row_mask:0xf bank_mask:0xf
    v_mfma_f32_16x16x32_bf16 v[24:27], v[72:75], a[88:91], v[24:27]
    ds_read_b64_tr_b16 v[66:67], v14 offset:33280
    v_fmac_f32_dpp v51, v51, v119 quad_perm:[1,0,3,2] row_mask:0xf bank_mask:0xf
    v_cvt_pk_bf16_f32 v142, v48, v49
    v_mfma_f32_16x16x32_bf16 v[28:31], v[72:75], a[92:95], v[28:31]
    buffer_load_dwordx4 v11, s[8:11], s61 offen offset:1024 lds
    v_cvt_pk_bf16_f32 v143, v50, v51
    v_mfma_f32_16x16x32_bf16 v[32:35], v[72:75], a[96:99], v[32:35]
    ds_write_b64 v120, v[140:141] offset:128
    v_mfma_f32_16x16x32_bf16 v[16:19], v[76:79], a[100:103], v[16:19]
    v_fmac_f32_dpp v52, v52, v116 quad_perm:[3,2,1,0] row_mask:0xf bank_mask:0xf
    v_fmac_f32_dpp v53, v53, v115 quad_perm:[3,2,1,0] row_mask:0xf bank_mask:0xf
    v_mfma_f32_16x16x32_bf16 v[20:23], v[76:79], a[104:107], v[20:23]
    s_add_u32 m0, s60, 8192
    ds_write_b64 v120, v[142:143] offset:192
    v_fmac_f32_dpp v54, v54, v115 quad_perm:[3,2,1,0] row_mask:0xf bank_mask:0xf
    v_fmac_f32_dpp v55, v55, v115 quad_perm:[3,2,1,0] row_mask:0xf bank_mask:0xf
    v_mfma_f32_16x16x32_bf16 v[24:27], v[76:79], a[108:111], v[24:27]
    s_add_u32 s61, s61, s35
    v_fmac_f32_dpp v52, v52, v119 quad_perm:[1,0,3,2] row_mask:0xf bank_mask:0xf
    v_fmac_f32_dpp v53, v53, v119 quad_perm:[1,0,3,2] row_mask:0xf bank_mask:0xf
    v_mfma_f32_16x16x32_bf16 v[28:31], v[76:79], a[112:115], v[28:31]
    buffer_load_dwordx4 v10, s[8:11], s61 offen offset:0 lds
    v_fmac_f32_dpp v54, v54, v119 quad_perm:[1,0,3,2] row_mask:0xf bank_mask:0xf
    v_fmac_f32_dpp v55, v55, v119 quad_perm:[1,0,3,2] row_mask:0xf bank_mask:0xf
    v_mfma_f32_16x16x32_bf16 v[32:35], v[76:79], a[116:119], v[32:35]
    v_cvt_pk_bf16_f32 v144, v52, v53
    v_cvt_pk_bf16_f32 v145, v54, v55
    s_waitcnt lgkmcnt(2)
    v_mfma_f32_16x16x32_bf16 v[16:19], v[56:59], a[120:123], v[16:19]
    ds_write_b64 v120, v[144:145] offset:256
    v_mfma_f32_16x16x32_bf16 v[20:23], v[56:59], a[124:127], v[20:23]
    ds_read_b64_tr_b16 v[68:69], v14 offset:36864
    v_mfma_f32_16x16x32_bf16 v[24:27], v[56:59], a[128:131], v[24:27]
    ds_read_b64_tr_b16 v[70:71], v14 offset:37376
    v_mfma_f32_16x16x32_bf16 v[28:31], v[56:59], a[132:135], v[28:31]
    buffer_load_dwordx4 v11, s[8:11], s61 offen offset:1024 lds
    v_mfma_f32_16x16x32_bf16 v[32:35], v[56:59], a[136:139], v[32:35]
    ds_read_b64_tr_b16 v[72:73], v14 offset:40960
    v_mfma_f32_16x16x32_bf16 v[16:19], v[60:63], a[140:143], v[16:19]
    ds_read_b64_tr_b16 v[74:75], v14 offset:41472
    v_mfma_f32_16x16x32_bf16 v[20:23], v[60:63], a[144:147], v[20:23]
    ds_read_b64_tr_b16 v[76:77], v14 offset:45056
    s_add_u32 m0, s60, 16384
    v_mfma_f32_16x16x32_bf16 v[24:27], v[60:63], a[148:151], v[24:27]
    ds_read_b64_tr_b16 v[78:79], v14 offset:45568
    s_add_u32 s61, s61, s35
    v_mfma_f32_16x16x32_bf16 v[28:31], v[60:63], a[152:155], v[28:31]
    buffer_load_dwordx4 v10, s[8:11], s61 offen offset:0 lds
    v_mfma_f32_16x16x32_bf16 v[32:35], v[60:63], a[156:159], v[32:35]
    ds_read_b128 v[88:91], v100
    v_mfma_f32_16x16x32_bf16 v[16:19], v[64:67], a[160:163], v[16:19]
    ds_read_b128 v[92:95], v100 offset:960
    v_mfma_f32_16x16x32_bf16 v[20:23], v[64:67], a[164:167], v[20:23]
    v_mfma_f32_16x16x32_bf16 v[24:27], v[64:67], a[168:171], v[24:27]
    v_mfma_f32_16x16x32_bf16 v[28:31], v[64:67], a[172:175], v[28:31]
    buffer_load_dwordx4 v11, s[8:11], s61 offen offset:1024 lds
    v_mfma_f32_16x16x32_bf16 v[32:35], v[64:67], a[176:179], v[32:35]
    s_waitcnt lgkmcnt(0)
    v_mfma_f32_16x16x32_bf16 v[16:19], v[68:71], a[180:183], v[16:19]
    s_waitcnt vmcnt(6)
    s_barrier
    buffer_store_dwordx4 v[88:91], v101, s[16:19], 0 offen sc1
    v_mfma_f32_16x16x32_bf16 v[20:23], v[68:71], a[184:187], v[20:23]
    ds_read_b64_tr_b16 v[56:57], v14 offset:49152
    s_add_u32 m0, s60, 24576
    buffer_store_dwordx4 v[92:95], v102, s[16:19], 0 offen sc1
    v_mfma_f32_16x16x32_bf16 v[24:27], v[68:71], a[188:191], v[24:27]
    ds_read_b64_tr_b16 v[58:59], v14 offset:49664
    s_add_u32 s61, s61, s35
    buffer_store_dwordx4 v[146:149], v150, s[16:19], s78 offen offset:2560 sc1
    v_mfma_f32_16x16x32_bf16 v[28:31], v[68:71], a[192:195], v[28:31]
    buffer_load_dwordx4 v10, s[8:11], s61 offen offset:0 lds
    s_mov_b32 s24, s54
    s_mov_b32 s25, s55
    v_mfma_f32_16x16x32_bf16 v[32:35], v[68:71], a[196:199], v[32:35]
    ds_read_b64_tr_b16 v[60:61], v14 offset:53248
    s_mov_b32 s26, 2359296
    s_mov_b32 s27, 0x20000
    v_mfma_f32_16x16x32_bf16 v[16:19], v[72:75], a[200:203], v[16:19]
    ds_read_b64_tr_b16 v[62:63], v14 offset:53760
    s_mov_b32 s28, s50
    v_mfma_f32_16x16x32_bf16 v[20:23], v[72:75], a[204:207], v[20:23]
    ds_read_b64_tr_b16 v[64:65], v14 offset:57344
    s_mov_b32 s29, s51
    s_mov_b32 s30, 5308416
    v_mfma_f32_16x16x32_bf16 v[24:27], v[72:75], a[208:211], v[24:27]
    ds_read_b64_tr_b16 v[66:67], v14 offset:57856
    s_mov_b32 s31, 0x20000
    v_add_u32 v13, 8192, v13
    v_mfma_f32_16x16x32_bf16 v[28:31], v[72:75], a[212:215], v[28:31]
    buffer_load_dwordx4 v11, s[8:11], s61 offen offset:1024 lds
    v_mfma_f32_16x16x32_bf16 v[32:35], v[72:75], a[216:219], v[32:35]
    s_and_b32 s68, s3, 1
    s_lshl_b32 s68, s68, 9
    s_lshr_b32 s70, s3, 1
    v_mfma_f32_16x16x32_bf16 v[16:19], v[76:79], a[220:223], v[16:19]
    s_mul_i32 s71, s70, 5120
    s_add_u32 s68, s68, s71
    s_add_u32 s68, s68, 81920
    v_mfma_f32_16x16x32_bf16 v[20:23], v[76:79], a[224:227], v[20:23]
    s_add_u32 m0, s60, 32768
    v_lshrrev_b32 v4, 1, v3
    v_lshl_add_u32 v4, v4, 4, v2
    v_mfma_f32_16x16x32_bf16 v[24:27], v[76:79], a[228:231], v[24:27]
    s_add_u32 s61, s61, s35
    v_lshlrev_b32 v4, 4, v4
    v_and_b32 v5, 1, v3
    v_mfma_f32_16x16x32_bf16 v[28:31], v[76:79], a[232:235], v[28:31]
    buffer_load_dwordx4 v10, s[8:11], s61 offen offset:0 lds
    v_mfma_f32_16x16x32_bf16 v[32:35], v[76:79], a[236:239], v[32:35]
    v_lshl_add_u32 v4, v5, 3, v4
    s_waitcnt lgkmcnt(0)
    v_mfma_f32_16x16x32_bf16 v[16:19], v[56:59], a[240:243], v[16:19]
    v_mfma_f32_16x16x32_bf16 v[20:23], v[56:59], a[244:247], v[20:23]
    ds_read_b64_tr_b16 v[68:69], v14 offset:61440
    v_mfma_f32_16x16x32_bf16 v[24:27], v[56:59], a[248:251], v[24:27]
    ds_read_b64_tr_b16 v[70:71], v14 offset:61952
    v_mfma_f32_16x16x32_bf16 v[28:31], v[56:59], a[252:255], v[28:31]
    buffer_load_dwordx4 v11, s[8:11], s61 offen offset:1024 lds
    v_add_u32 v112, s68, v4
    v_lshlrev_b32 v124, 4, v1
    v_mfma_f32_16x16x32_bf16 v[32:35], v[56:59], v[152:155], v[32:35]
    ds_read_b64_tr_b16 v[72:73], v15 offset:0
    v_lshlrev_b32 v125, 3, v1
    v_add_u32 v113, 81920, v124
    v_mfma_f32_16x16x32_bf16 v[16:19], v[60:63], v[156:159], v[16:19]
    ds_read_b64_tr_b16 v[74:75], v15 offset:512
    v_add_u32 v114, 122880, v124
    v_mfma_f32_16x16x32_bf16 v[20:23], v[60:63], v[160:163], v[20:23]
    ds_read_b64_tr_b16 v[76:77], v15 offset:4096
    s_add_u32 m0, s60, 40960
    s_lshl_b32 s99, s5, 3
    s_add_u32 s64, s101, 0
    v_mfma_f32_16x16x32_bf16 v[24:27], v[60:63], v[164:167], v[24:27]
    ds_read_b64_tr_b16 v[78:79], v15 offset:4608
    s_add_u32 s61, s61, s35
    s_and_b32 s64, s64, 7
    s_add_u32 s64, s64, s99
    v_mfma_f32_16x16x32_bf16 v[28:31], v[60:63], v[168:171], v[28:31]
    buffer_load_dwordx4 v10, s[8:11], s61 offen offset:0 lds
    v_mfma_f32_16x16x32_bf16 v[32:35], v[60:63], v[172:175], v[32:35]
    s_mul_i32 s64, s64, 73728
    s_add_u32 s65, s101, 1
    s_and_b32 s65, s65, 7
    v_mfma_f32_16x16x32_bf16 v[16:19], v[64:67], v[176:179], v[16:19]
    s_add_u32 s65, s65, s99
    s_mul_i32 s65, s65, 73728
    s_add_u32 s66, s101, 2
    v_mfma_f32_16x16x32_bf16 v[20:23], v[64:67], v[180:183], v[20:23]
    s_and_b32 s66, s66, 7
    s_add_u32 s66, s66, s99
    v_mfma_f32_16x16x32_bf16 v[24:27], v[64:67], v[184:187], v[24:27]
    s_mul_i32 s66, s66, 73728
    s_add_u32 s67, s101, 3
    v_mfma_f32_16x16x32_bf16 v[28:31], v[64:67], v[188:191], v[28:31]
    buffer_load_dwordx4 v11, s[8:11], s61 offen offset:1024 lds
    v_mfma_f32_16x16x32_bf16 v[32:35], v[64:67], v[192:195], v[32:35]
    s_and_b32 s67, s67, 7
    s_waitcnt lgkmcnt(0)
    v_mfma_f32_16x16x32_bf16 v[16:19], v[68:71], v[196:199], v[16:19]
    s_waitcnt vmcnt(9)
    s_barrier
    v_mfma_f32_16x16x32_bf16 v[20:23], v[68:71], v[200:203], v[20:23]
    ds_read_b64_tr_b16 v[56:57], v14 offset:0
    s_add_u32 m0, s60, 49152
    v_mfma_f32_16x16x32_bf16 v[24:27], v[68:71], v[204:207], v[24:27]
    ds_read_b64_tr_b16 v[58:59], v14 offset:512
    s_add_u32 s61, s61, s35
    v_mfma_f32_16x16x32_bf16 v[28:31], v[68:71], v[208:211], v[28:31]
    buffer_load_dwordx4 v10, s[8:11], s61 offen offset:0 lds
    s_add_u32 s67, s67, s99
    s_mul_i32 s67, s67, 73728
    v_mfma_f32_16x16x32_bf16 v[32:35], v[68:71], v[212:215], v[32:35]
    ds_read_b64_tr_b16 v[60:61], v14 offset:4096
    s_add_u32 s68, s101, 4
    v_mfma_f32_16x16x32_bf16 v[16:19], v[72:75], v[216:219], v[16:19]
    ds_read_b64_tr_b16 v[62:63], v14 offset:4608
    s_and_b32 s68, s68, 7
    s_add_u32 s68, s68, s99
    v_mfma_f32_16x16x32_bf16 v[20:23], v[72:75], v[220:223], v[20:23]
    ds_read_b64_tr_b16 v[64:65], v14 offset:8192
    s_mul_i32 s68, s68, 73728
    v_mfma_f32_16x16x32_bf16 v[24:27], v[72:75], v[224:227], v[24:27]
    ds_read_b64_tr_b16 v[66:67], v14 offset:8704
    s_add_u32 s69, s101, 5
    s_and_b32 s69, s69, 7
    v_mfma_f32_16x16x32_bf16 v[28:31], v[72:75], v[228:231], v[28:31]
    buffer_load_dwordx4 v11, s[8:11], s61 offen offset:1024 lds
    v_mfma_f32_16x16x32_bf16 v[32:35], v[72:75], v[232:235], v[32:35]
    s_add_u32 s69, s69, s99
    s_mul_i32 s69, s69, 73728
    s_add_u32 s70, s101, 6
    v_mfma_f32_16x16x32_bf16 v[36:39], v[76:79], v[236:239], v[16:19]
    s_and_b32 s70, s70, 7
    s_add_u32 s70, s70, s99
    s_mul_i32 s70, s70, 73728
    v_mfma_f32_16x16x32_bf16 v[40:43], v[76:79], v[240:243], v[20:23]
    s_add_u32 m0, s60, 57344
    s_add_u32 s71, s101, 7
    v_mfma_f32_16x16x32_bf16 v[44:47], v[76:79], v[244:247], v[24:27]
    s_add_u32 s61, s61, s35
    s_and_b32 s71, s71, 7
    s_add_u32 s71, s71, s99
    v_mfma_f32_16x16x32_bf16 v[48:51], v[76:79], v[248:251], v[28:31]
    buffer_load_dwordx4 v10, s[8:11], s61 offen offset:0 lds
    v_mfma_f32_16x16x32_bf16 v[52:55], v[76:79], v[252:255], v[32:35]
    s_mul_i32 s71, s71, 73728
    s_waitcnt lgkmcnt(0)
L_g1:
    v_mfma_f32_16x16x32_bf16 v[16:19], v[56:59], a[0:3], 0
    v_mfma_f32_16x16x32_bf16 v[20:23], v[56:59], a[4:7], 0
    ds_read_b64_tr_b16 v[68:69], v14 offset:12288
    v_mfma_f32_16x16x32_bf16 v[24:27], v[56:59], a[8:11], 0
    ds_read_b64_tr_b16 v[70:71], v14 offset:12800
    v_mfma_f32_16x16x32_bf16 v[28:31], v[56:59], a[12:15], 0
    buffer_load_dwordx4 v11, s[8:11], s61 offen offset:1024 lds
    v_cvt_pk_bf16_f32 v88, v36, v37
    v_mfma_f32_16x16x32_bf16 v[32:35], v[56:59], a[16:19], 0
    ds_read_b64_tr_b16 v[72:73], v14 offset:16384
    v_cvt_pk_bf16_f32 v89, v38, v39
    v_mfma_f32_16x16x32_bf16 v[16:19], v[60:63], a[20:23], v[16:19]
    ds_read_b64_tr_b16 v[74:75], v14 offset:16896
    v_pk_max_i16 v88, v88, 0
    v_mfma_f32_16x16x32_bf16 v[20:23], v[60:63], a[24:27], v[20:23]
    ds_read_b64_tr_b16 v[76:77], v14 offset:20480
    s_add_u32 m0, s60, 65536
    v_pk_max_i16 v89, v89, 0
    v_mfma_f32_16x16x32_bf16 v[24:27], v[60:63], a[28:31], v[24:27]
    ds_read_b64_tr_b16 v[78:79], v14 offset:20992
    s_add_u32 s61, s61, s35
    v_mfma_f32_16x16x32_bf16 v[28:31], v[60:63], a[32:35], v[28:31]
    buffer_load_dwordx4 v10, s[8:11], s61 offen offset:0 lds
    v_mfma_f32_16x16x32_bf16 v[32:35], v[60:63], a[36:39], v[32:35]
    ds_write_b64 v112, v[88:89] offset:0
    v_mfma_f32_16x16x32_bf16 v[16:19], v[64:67], a[40:43], v[16:19]
    v_mfma_f32_16x16x32_bf16 v[20:23], v[64:67], a[44:47], v[20:23]
    s_add_u32 s73, s73, 128
    s_and_b32 s73, s73, 0x380
    v_mfma_f32_16x16x32_bf16 v[24:27], v[64:67], a[48:51], v[24:27]
    s_add_u32 s62, s73, s74
    v_mfma_f32_16x16x32_bf16 v[28:31], v[64:67], a[52:55], v[28:31]
    buffer_load_dwordx4 v11, s[8:11], s61 offen offset:1024 lds
    v_mfma_f32_16x16x32_bf16 v[32:35], v[64:67], a[56:59], v[32:35]
    s_waitcnt lgkmcnt(1)
    v_mfma_f32_16x16x32_bf16 v[16:19], v[68:71], a[60:63], v[16:19]
    s_waitcnt vmcnt(6)
    s_barrier
    v_mfma_f32_16x16x32_bf16 v[20:23], v[68:71], a[64:67], v[20:23]
    ds_read_b64_tr_b16 v[56:57], v14 offset:24576
    s_add_u32 m0, s60, 0
    v_mfma_f32_16x16x32_bf16 v[24:27], v[68:71], a[68:71], v[24:27]
    ds_read_b64_tr_b16 v[58:59], v14 offset:25088
    s_mov_b32 s61, s62
    v_mfma_f32_16x16x32_bf16 v[28:31], v[68:71], a[72:75], v[28:31]
    buffer_load_dwordx4 v10, s[8:11], s61 offen offset:0 lds
    v_cvt_pk_bf16_f32 v90, v40, v41
    v_mfma_f32_16x16x32_bf16 v[32:35], v[68:71], a[76:79], v[32:35]
    ds_read_b64_tr_b16 v[60:61], v14 offset:28672
    v_cvt_pk_bf16_f32 v91, v42, v43
    v_mfma_f32_16x16x32_bf16 v[16:19], v[72:75], a[80:83], v[16:19]
    ds_read_b64_tr_b16 v[62:63], v14 offset:29184
    v_pk_max_i16 v90, v90, 0
    v_mfma_f32_16x16x32_bf16 v[20:23], v[72:75], a[84:87], v[20:23]
    ds_read_b64_tr_b16 v[64:65], v14 offset:32768
    v_pk_max_i16 v91, v91, 0
    v_mfma_f32_16x16x32_bf16 v[24:27], v[72:75], a[88:91], v[24:27]
    ds_read_b64_tr_b16 v[66:67], v14 offset:33280
    v_mfma_f32_16x16x32_bf16 v[28:31], v[72:75], a[92:95], v[28:31]
    buffer_load_dwordx4 v11, s[8:11], s61 offen offset:1024 lds
    v_mfma_f32_16x16x32_bf16 v[32:35], v[72:75], a[96:99], v[32:35]
    s_cmp_eq_u32 s63, 6
    s_cbranch_scc1 L_once1
L_once1_ret:
    ds_write_b64 v112, v[90:91] offset:1024
    v_mfma_f32_16x16x32_bf16 v[16:19], v[76:79], a[100:103], v[16:19]
    v_mfma_f32_16x16x32_bf16 v[20:23], v[76:79], a[104:107], v[20:23]
    s_add_u32 m0, s60, 8192
    v_mfma_f32_16x16x32_bf16 v[24:27], v[76:79], a[108:111], v[24:27]
    s_add_u32 s61, s61, s35
    v_mfma_f32_16x16x32_bf16 v[28:31], v[76:79], a[112:115], v[28:31]
    buffer_load_dwordx4 v10, s[8:11], s61 offen offset:0 lds
    v_mfma_f32_16x16x32_bf16 v[32:35], v[76:79], a[116:119], v[32:35]
    s_waitcnt lgkmcnt(1)
    v_mfma_f32_16x16x32_bf16 v[16:19], v[56:59], a[120:123], v[16:19]
    v_mfma_f32_16x16x32_bf16 v[20:23], v[56:59], a[124:127], v[20:23]
    ds_read_b64_tr_b16 v[68:69], v14 offset:36864
    v_mfma_f32_16x16x32_bf16 v[24:27], v[56:59], a[128:131], v[24:27]
    ds_read_b64_tr_b16 v[70:71], v14 offset:37376
    v_mfma_f32_16x16x32_bf16 v[28:31], v[56:59], a[132:135], v[28:31]
    buffer_load_dwordx4 v11, s[8:11], s61 offen offset:1024 lds
    v_cvt_pk_bf16_f32 v92, v44, v45
    v_mfma_f32_16x16x32_bf16 v[32:35], v[56:59], a[136:139], v[32:35]
    ds_read_b64_tr_b16 v[72:73], v14 offset:40960
    v_cvt_pk_bf16_f32 v93, v46, v47
    v_mfma_f32_16x16x32_bf16 v[16:19], v[60:63], a[140:143], v[16:19]
    ds_read_b64_tr_b16 v[74:75], v14 offset:41472
    v_pk_max_i16 v92, v92, 0
    v_mfma_f32_16x16x32_bf16 v[20:23], v[60:63], a[144:147], v[20:23]
    ds_read_b64_tr_b16 v[76:77], v14 offset:45056
    s_add_u32 m0, s60, 16384
    v_pk_max_i16 v93, v93, 0
    v_mfma_f32_16x16x32_bf16 v[24:27], v[60:63], a[148:151], v[24:27]
    ds_read_b64_tr_b16 v[78:79], v14 offset:45568
    s_add_u32 s61, s61, s35
    v_mfma_f32_16x16x32_bf16 v[28:31], v[60:63], a[152:155], v[28:31]
    buffer_load_dwordx4 v10, s[8:11], s61 offen offset:0 lds
    v_mfma_f32_16x16x32_bf16 v[32:35], v[60:63], a[156:159], v[32:35]
    ds_write_b64 v112, v[92:93] offset:2048
    v_mfma_f32_16x16x32_bf16 v[16:19], v[64:67], a[160:163], v[16:19]
    v_mfma_f32_16x16x32_bf16 v[20:23], v[64:67], a[164:167], v[20:23]
    v_mfma_f32_16x16x32_bf16 v[24:27], v[64:67], a[168:171], v[24:27]
    v_mfma_f32_16x16x32_bf16 v[28:31], v[64:67], a[172:175], v[28:31]
    buffer_load_dwordx4 v11, s[8:11], s61 offen offset:1024 lds
    v_mfma_f32_16x16x32_bf16 v[32:35], v[64:67], a[176:179], v[32:35]
    s_waitcnt lgkmcnt(1)
    v_mfma_f32_16x16x32_bf16 v[16:19], v[68:71], a[180:183], v[16:19]
    s_waitcnt vmcnt(6)
    s_barrier
    v_mfma_f32_16x16x32_bf16 v[20:23], v[68:71], a[184:187], v[20:23]
    ds_read_b64_tr_b16 v[56:57], v14 offset:49152
    s_add_u32 m0, s60, 24576
    v_mfma_f32_16x16x32_bf16 v[24:27], v[68:71], a[188:191], v[24:27]
    ds_read_b64_tr_b16 v[58:59], v14 offset:49664
    s_add_u32 s61, s61, s35
    v_mfma_f32_16x16x32_bf16 v[28:31], v[68:71], a[192:195], v[28:31]
    buffer_load_dwordx4 v10, s[8:11], s61 offen offset:0 lds
    v_cvt_pk_bf16_f32 v94, v48, v49
    v_mfma_f32_16x16x32_bf16 v[32:35], v[68:71], a[196:199], v[32:35]
    ds_read_b64_tr_b16 v[60:61], v14 offset:53248
    v_cvt_pk_bf16_f32 v95, v50, v51
    v_mfma_f32_16x16x32_bf16 v[16:19], v[72:75], a[200:203], v[16:19]
    ds_read_b64_tr_b16 v[62:63], v14 offset:53760
    v_pk_max_i16 v94, v94, 0
    v_mfma_f32_16x16x32_bf16 v[20:23], v[72:75], a[204:207], v[20:23]
    ds_read_b64_tr_b16 v[64:65], v14 offset:57344
    v_pk_max_i16 v95, v95, 0
    v_mfma_f32_16x16x32_bf16 v[24:27], v[72:75], a[208:211], v[24:27]
    ds_read_b64_tr_b16 v[66:67], v14 offset:57856
    v_mfma_f32_16x16x32_bf16 v[28:31], v[72:75], a[212:215], v[28:31]
    buffer_load_dwordx4 v11, s[8:11], s61 offen offset:1024 lds
    v_mfma_f32_16x16x32_bf16 v[32:35], v[72:75], a[216:219], v[32:35]
    ds_write_b64 v112, v[94:95] offset:3072
    v_mfma_f32_16x16x32_bf16 v[16:19], v[76:79], a[220:223], v[16:19]
    v_mfma_f32_16x16x32_bf16 v[20:23], v[76:79], a[224:227], v[20:23]
    s_add_u32 m0, s60, 32768
    v_mfma_f32_16x16x32_bf16 v[24:27], v[76:79], a[228:231], v[24:27]
    s_add_u32 s61, s61, s35
    v_mfma_f32_16x16x32_bf16 v[28:31], v[76:79], a[232:235], v[28:31]
    buffer_load_dwordx4 v10, s[8:11], s61 offen offset:0 lds
    v_mfma_f32_16x16x32_bf16 v[32:35], v[76:79], a[236:239], v[32:35]
    s_waitcnt lgkmcnt(1)
    v_mfma_f32_16x16x32_bf16 v[16:19], v[56:59], a[240:243], v[16:19]
    v_mfma_f32_16x16x32_bf16 v[20:23], v[56:59], a[244:247], v[20:23]
    ds_read_b64_tr_b16 v[68:69], v14 offset:61440
    v_mfma_f32_16x16x32_bf16 v[24:27], v[56:59], a[248:251], v[24:27]
    ds_read_b64_tr_b16 v[70:71], v14 offset:61952
    v_mfma_f32_16x16x32_bf16 v[28:31], v[56:59], a[252:255], v[28:31]
    buffer_load_dwordx4 v11, s[8:11], s61 offen offset:1024 lds
    v_cvt_pk_bf16_f32 v96, v52, v53
    v_mfma_f32_16x16x32_bf16 v[32:35], v[56:59], v[152:155], v[32:35]
    ds_read_b64_tr_b16 v[72:73], v15 offset:0
    v_cvt_pk_bf16_f32 v97, v54, v55
    v_mfma_f32_16x16x32_bf16 v[16:19], v[60:63], v[156:159], v[16:19]
    ds_read_b64_tr_b16 v[74:75], v15 offset:512
    v_pk_max_i16 v96, v96, 0
    v_mfma_f32_16x16x32_bf16 v[20:23], v[60:63], v[160:163], v[20:23]
    ds_read_b64_tr_b16 v[76:77], v15 offset:4096
    s_add_u32 m0, s60, 40960
    v_pk_max_i16 v97, v97, 0
    v_mfma_f32_16x16x32_bf16 v[24:27], v[60:63], v[164:167], v[24:27]
    ds_read_b64_tr_b16 v[78:79], v15 offset:4608
    s_add_u32 s61, s61, s35
    v_mfma_f32_16x16x32_bf16 v[28:31], v[60:63], v[168:171], v[28:31]
    buffer_load_dwordx4 v10, s[8:11], s61 offen offset:0 lds
    v_mfma_f32_16x16x32_bf16 v[32:35], v[60:63], v[172:175], v[32:35]
    ds_write_b64 v112, v[96:97] offset:4096
    v_mfma_f32_16x16x32_bf16 v[16:19], v[64:67], v[176:179], v[16:19]
    v_mfma_f32_16x16x32_bf16 v[20:23], v[64:67], v[180:183], v[20:23]
    v_mfma_f32_16x16x32_bf16 v[24:27], v[64:67], v[184:187], v[24:27]
    v_mfma_f32_16x16x32_bf16 v[28:31], v[64:67], v[188:191], v[28:31]
    buffer_load_dwordx4 v11, s[8:11], s61 offen offset:1024 lds
    v_mfma_f32_16x16x32_bf16 v[32:35], v[64:67], v[192:195], v[32:35]
    s_waitcnt lgkmcnt(1)
    v_mfma_f32_16x16x32_bf16 v[16:19], v[68:71], v[196:199], v[16:19]
    s_waitcnt vmcnt(6)
    s_barrier
    v_mfma_f32_16x16x32_bf16 v[20:23], v[68:71], v[200:203], v[20:23]
    ds_read_b64_tr_b16 v[56:57], v14 offset:0
    s_add_u32 m0, s60, 49152
    v_mfma_f32_16x16x32_bf16 v[24:27], v[68:71], v[204:207], v[24:27]
    ds_read_b64_tr_b16 v[58:59], v14 offset:512
    s_add_u32 s61, s61, s35
    v_mfma_f32_16x16x32_bf16 v[28:31], v[68:71], v[208:211], v[28:31]
    buffer_load_dwordx4 v10, s[8:11], s61 offen offset:0 lds
    v_mfma_f32_16x16x32_bf16 v[32:35], v[68:71], v[212:215], v[32:35]
    ds_read_b64_tr_b16 v[60:61], v14 offset:4096
    v_mfma_f32_16x16x32_bf16 v[16:19], v[72:75], v[216:219], v[16:19]
    ds_read_b64_tr_b16 v[62:63], v14 offset:4608
    v_mfma_f32_16x16x32_bf16 v[20:23], v[72:75], v[220:223], v[20:23]
    ds_read_b64_tr_b16 v[64:65], v14 offset:8192
    v_mfma_f32_16x16x32_bf16 v[24:27], v[72:75], v[224:227], v[24:27]
    ds_read_b64_tr_b16 v[66:67], v14 offset:8704
    v_mfma_f32_16x16x32_bf16 v[28:31], v[72:75], v[228:231], v[28:31]
    buffer_load_dwordx4 v11, s[8:11], s61 offen offset:1024 lds
    v_mfma_f32_16x16x32_bf16 v[32:35], v[72:75], v[232:235], v[32:35]
    v_mfma_f32_16x16x32_bf16 v[36:39], v[76:79], v[236:239], v[16:19]
    v_add_u32 v112, 10240, v112
    v_mfma_f32_16x16x32_bf16 v[40:43], v[76:79], v[240:243], v[20:23]
    s_add_u32 m0, s60, 57344
    v_mfma_f32_16x16x32_bf16 v[44:47], v[76:79], v[244:247], v[24:27]
    s_add_u32 s61, s61, s35
    v_mfma_f32_16x16x32_bf16 v[48:51], v[76:79], v[248:251], v[28:31]
    buffer_load_dwordx4 v10, s[8:11], s61 offen offset:0 lds
    s_sub_u32 s63, s63, 1
    s_cmp_lg_u32 s63, 0
    v_mfma_f32_16x16x32_bf16 v[52:55], v[76:79], v[252:255], v[32:35]
    s_waitcnt lgkmcnt(0)
    s_cbranch_scc1 L_g1
    v_mfma_f32_16x16x32_bf16 v[16:19], v[56:59], a[0:3], 0
    v_mfma_f32_16x16x32_bf16 v[20:23], v[56:59], a[4:7], 0
    ds_read_b64_tr_b16 v[68:69], v14 offset:12288
    v_mfma_f32_16x16x32_bf16 v[24:27], v[56:59], a[8:11], 0
    ds_read_b64_tr_b16 v[70:71], v14 offset:12800
    v_mfma_f32_16x16x32_bf16 v[28:31], v[56:59], a[12:15], 0
    buffer_load_dwordx4 v11, s[8:11], s61 offen offset:1024 lds
    v_cvt_pk_bf16_f32 v88, v36, v37
    v_mfma_f32_16x16x32_bf16 v[32:35], v[56:59], a[16:19], 0
    ds_read_b64_tr_b16 v[72:73], v14 offset:16384
    v_cvt_pk_bf16_f32 v89, v38, v39
    v_mfma_f32_16x16x32_bf16 v[16:19], v[60:63], a[20:23], v[16:19]
    ds_read_b64_tr_b16 v[74:75], v14 offset:16896
    v_pk_max_i16 v88, v88, 0
    v_mfma_f32_16x16x32_bf16 v[20:23], v[60:63], a[24:27], v[20:23]
    ds_read_b64_tr_b16 v[76:77], v14 offset:20480
    s_add_u32 m0, s60, 65536
    v_pk_max_i16 v89, v89, 0
    v_mfma_f32_16x16x32_bf16 v[24:27], v[60:63], a[28:31], v[24:27]
    ds_read_b64_tr_b16 v[78:79], v14 offset:20992
    s_add_u32 s61, s61, s35
    v_mfma_f32_16x16x32_bf16 v[28:31], v[60:63], a[32:35], v[28:31]
    buffer_load_dwordx4 v10, s[8:11], s61 offen offset:0 lds
    v_mfma_f32_16x16x32_bf16 v[32:35], v[60:63], a[36:39], v[32:35]
    ds_write_b64 v112, v[88:89] offset:0
    v_mfma_f32_16x16x32_bf16 v[16:19], v[64:67], a[40:43], v[16:19]
    v_mfma_f32_16x16x32_bf16 v[20:23], v[64:67], a[44:47], v[20:23]
    s_mov_b32 s62, s72
    v_mfma_f32_16x16x32_bf16 v[24:27], v[64:67], a[48:51], v[24:27]
    v_mfma_f32_16x16x32_bf16 v[28:31], v[64:67], a[52:55], v[28:31]
    buffer_load_dwordx4 v11, s[8:11], s61 offen offset:1024 lds
    v_mfma_f32_16x16x32_bf16 v[32:35], v[64:67], a[56:59], v[32:35]
    s_waitcnt lgkmcnt(1)
    v_mfma_f32_16x16x32_bf16 v[16:19], v[68:71], a[60:63], v[16:19]
    s_waitcnt vmcnt(6)
    s_barrier
    v_mfma_f32_16x16x32_bf16 v[20:23], v[68:71], a[64:67], v[20:23]
    ds_read_b64_tr_b16 v[56:57], v14 offset:24576
    s_add_u32 m0, s60, 0
    ds_read_b128 a[0:3], v113 offset:0
    v_mfma_f32_16x16x32_bf16 v[24:27], v[68:71], a[68:71], v[24:27]
    ds_read_b64_tr_b16 v[58:59], v14 offset:25088
    s_add_u32 s61, s62, s64
    ds_read_b128 a[4:7], v113 offset:1024
    v_mfma_f32_16x16x32_bf16 v[28:31], v[68:71], a[72:75], v[28:31]
    buffer_load_dwordx4 v12, s[28:31], s61 offen offset:0 lds
    v_cvt_pk_bf16_f32 v90, v40, v41
    v_mfma_f32_16x16x32_bf16 v[32:35], v[68:71], a[76:79], v[32:35]
    ds_read_b64_tr_b16 v[60:61], v14 offset:28672
    ds_read_b128 a[8:11], v113 offset:2048
    v_mfma_f32_16x16x32_bf16 v[16:19], v[72:75], a[80:83], v[16:19]
    ds_read_b64_tr_b16 v[62:63], v14 offset:29184
    ds_read_b128 a[12:15], v113 offset:3072
    v_mfma_f32_16x16x32_bf16 v[20:23], v[72:75], a[84:87], v[20:23]
    ds_read_b64_tr_b16 v[64:65], v14 offset:32768
    ds_read_b128 a[16:19], v113 offset:4096
    v_mfma_f32_16x16x32_bf16 v[24:27], v[72:75], a[88:91], v[24:27]
    ds_read_b64_tr_b16 v[66:67], v14 offset:33280
    ds_read_b128 a[20:23], v113 offset:5120
    v_mfma_f32_16x16x32_bf16 v[28:31], v[72:75], a[92:95], v[28:31]
    buffer_load_dwordx4 v13, s[28:31], s61 offen offset:1024 lds
    v_cvt_pk_bf16_f32 v91, v42, v43
    v_mfma_f32_16x16x32_bf16 v[32:35], v[72:75], a[96:99], v[32:35]
    ds_read_b128 a[24:27], v113 offset:6144
    ds_read_b128 a[28:31], v113 offset:7168
    v_mfma_f32_16x16x32_bf16 v[16:19], v[76:79], a[100:103], v[16:19]
    v_pk_max_i16 v90, v90, 0
    v_pk_max_i16 v91, v91, 0
    v_mfma_f32_16x16x32_bf16 v[20:23], v[76:79], a[104:107], v[20:23]
    s_add_u32 m0, s60, 8192
    ds_read_b128 a[32:35], v113 offset:8192
    v_mfma_f32_16x16x32_bf16 v[24:27], v[76:79], a[108:111], v[24:27]
    s_add_u32 s61, s62, s65
    ds_read_b128 a[36:39], v113 offset:9216
    v_mfma_f32_16x16x32_bf16 v[28:31], v[76:79], a[112:115], v[28:31]
    buffer_load_dwordx4 v12, s[28:31], s61 offen offset:0 lds
    ds_write_b64 v112, v[90:91] offset:1024
    v_mfma_f32_16x16x32_bf16 v[32:35], v[76:79], a[116:119], v[32:35]
    s_waitcnt lgkmcnt(6)
    v_mfma_f32_16x16x32_bf16 v[16:19], v[56:59], a[120:123], v[16:19]
    ds_read_b128 a[40:43], v113 offset:10240
    v_mfma_f32_16x16x32_bf16 v[20:23], v[56:59], a[124:127], v[20:23]
    ds_read_b64_tr_b16 v[68:69], v14 offset:36864
    v_mfma_f32_16x16x32_bf16 v[24:27], v[56:59], a[128:131], v[24:27]
    ds_read_b64_tr_b16 v[70:71], v14 offset:37376
    ds_read_b128 a[44:47], v113 offset:11264
    v_mfma_f32_16x16x32_bf16 v[28:31], v[56:59], a[132:135], v[28:31]
    buffer_load_dwordx4 v13, s[28:31], s61 offen offset:1024 lds
    v_cvt_pk_bf16_f32 v92, v44, v45
    v_mfma_f32_16x16x32_bf16 v[32:35], v[56:59], a[136:139], v[32:35]
    ds_read_b64_tr_b16 v[72:73], v14 offset:40960
    ds_read_b128 a[48:51], v113 offset:12288
    v_mfma_f32_16x16x32_bf16 v[16:19], v[60:63], a[140:143], v[16:19]
    ds_read_b64_tr_b16 v[74:75], v14 offset:41472
    ds_read_b128 a[52:55], v113 offset:13312
    v_mfma_f32_16x16x32_bf16 v[20:23], v[60:63], a[144:147], v[20:23]
    ds_read_b64_tr_b16 v[76:77], v14 offset:45056
    s_add_u32 m0, s60, 16384
    ds_read_b128 a[56:59], v113 offset:14336
    v_mfma_f32_16x16x32_bf16 v[24:27], v[60:63], a[148:151], v[24:27]
    ds_read_b64_tr_b16 v[78:79], v14 offset:45568
    s_add_u32 s61, s62, s66
    ds_read_b128 a[60:63], v113 offset:15360
    v_mfma_f32_16x16x32_bf16 v[28:31], v[60:63], a[152:155], v[28:31]
    buffer_load_dwordx4 v12, s[28:31], s61 offen offset:0 lds
    v_cvt_pk_bf16_f32 v93, v46, v47
    v_mfma_f32_16x16x32_bf16 v[32:35], v[60:63], a[156:159], v[32:35]
    ds_read_b128 a[64:67], v113 offset:16384
    ds_read_b128 a[68:71], v113 offset:17408
    v_mfma_f32_16x16x32_bf16 v[16:19], v[64:67], a[160:163], v[16:19]
    v_pk_max_i16 v92, v92, 0
    v_pk_max_i16 v93, v93, 0
    v_mfma_f32_16x16x32_bf16 v[20:23], v[64:67], a[164:167], v[20:23]
    ds_read_b128 a[72:75], v113 offset:18432
    v_mfma_f32_16x16x32_bf16 v[24:27], v[64:67], a[168:171], v[24:27]
    ds_read_b128 a[76:79], v113 offset:19456
    v_mfma_f32_16x16x32_bf16 v[28:31], v[64:67], a[172:175], v[28:31]
    buffer_load_dwordx4 v13, s[28:31], s61 offen offset:1024 lds
    ds_write_b64 v112, v[92:93] offset:2048
    v_mfma_f32_16x16x32_bf16 v[32:35], v[64:67], a[176:179], v[32:35]
    s_waitcnt lgkmcnt(6)
    v_mfma_f32_16x16x32_bf16 v[16:19], v[68:71], a[180:183], v[16:19]
    s_waitcnt vmcnt(6)
    s_barrier
    v_mfma_f32_16x16x32_bf16 v[20:23], v[68:71], a[184:187], v[20:23]
    ds_read_b64_tr_b16 v[56:57], v14 offset:49152
    s_add_u32 m0, s60, 24576
    ds_read_b128 a[80:83], v113 offset:20480
    v_mfma_f32_16x16x32_bf16 v[24:27], v[68:71], a[188:191], v[24:27]
    ds_read_b64_tr_b16 v[58:59], v14 offset:49664
    s_add_u32 s61, s62, s67
    ds_read_b128 a[84:87], v113 offset:21504
    v_mfma_f32_16x16x32_bf16 v[28:31], v[68:71], a[192:195], v[28:31]
    buffer_load_dwordx4 v12, s[28:31], s61 offen offset:0 lds
    v_cvt_pk_bf16_f32 v94, v48, v49
    v_mfma_f32_16x16x32_bf16 v[32:35], v[68:71], a[196:199], v[32:35]
    ds_read_b64_tr_b16 v[60:61], v14 offset:53248
    ds_read_b128 a[88:91], v113 offset:22528
    v_mfma_f32_16x16x32_bf16 v[16:19], v[72:75], a[200:203], v[16:19]
    ds_read_b64_tr_b16 v[62:63], v14 offset:53760
    ds_read_b128 a[92:95], v113 offset:23552
    v_mfma_f32_16x16x32_bf16 v[20:23], v[72:75], a[204:207], v[20:23]
    ds_read_b64_tr_b16 v[64:65], v14 offset:57344
    ds_read_b128 a[96:99], v113 offset:24576
    v_mfma_f32_16x16x32_bf16 v[24:27], v[72:75], a[208:211], v[24:27]
    ds_read_b64_tr_b16 v[66:67], v14 offset:57856
    ds_read_b128 a[100:103], v113 offset:25600
    v_mfma_f32_16x16x32_bf16 v[28:31], v[72:75], a[212:215], v[28:31]
    buffer_load_dwordx4 v13, s[28:31], s61 offen offset:1024 lds
    v_cvt_pk_bf16_f32 v95, v50, v51
    v_mfma_f32_16x16x32_bf16 v[32:35], v[72:75], a[216:219], v[32:35]
    ds_read_b128 a[104:107], v113 offset:26624
    ds_read_b128 a[108:111], v113 offset:27648
    v_mfma_f32_16x16x32_bf16 v[16:19], v[76:79], a[220:223], v[16:19]
    v_pk_max_i16 v94, v94, 0
    v_pk_max_i16 v95, v95, 0
    v_mfma_f32_16x16x32_bf16 v[20:23], v[76:79], a[224:227], v[20:23]
    s_add_u32 m0, s60, 32768
    ds_read_b128 a[112:115], v113 offset:28672
    v_mfma_f32_16x16x32_bf16 v[24:27], v[76:79], a[228:231], v[24:27]
    s_add_u32 s61, s62, s68
    ds_read_b128 a[116:119], v113 offset:29696
    v_mfma_f32_16x16x32_bf16 v[28:31], v[76:79], a[232:235], v[28:31]
    buffer_load_dwordx4 v12, s[28:31], s61 offen offset:0 lds
    ds_write_b64 v112, v[94:95] offset:3072
    v_mfma_f32_16x16x32_bf16 v[32:35], v[76:79], a[236:239], v[32:35]
    s_waitcnt lgkmcnt(6)
    v_mfma_f32_16x16x32_bf16 v[16:19], v[56:59], a[240:243], v[16:19]
    ds_read_b128 a[120:123], v113 offset:30720
    v_mfma_f32_16x16x32_bf16 v[20:23], v[56:59], a[244:247], v[20:23]
    ds_read_b64_tr_b16 v[68:69], v14 offset:61440
    v_mfma_f32_16x16x32_bf16 v[24:27], v[56:59], a[248:251], v[24:27]
    ds_read_b64_tr_b16 v[70:71], v14 offset:61952
    ds_read_b128 a[124:127], v113 offset:31744
    v_mfma_f32_16x16x32_bf16 v[28:31], v[56:59], a[252:255], v[28:31]
    buffer_load_dwordx4 v13, s[28:31], s61 offen offset:1024 lds
    v_cvt_pk_bf16_f32 v96, v52, v53
    v_mfma_f32_16x16x32_bf16 v[32:35], v[56:59], v[152:155], v[32:35]
    ds_read_b64_tr_b16 v[72:73], v15 offset:0
    ds_read_b128 a[128:131], v113 offset:32768
    v_mfma_f32_16x16x32_bf16 v[16:19], v[60:63], v[156:159], v[16:19]
    ds_read_b64_tr_b16 v[74:75], v15 offset:512
    ds_read_b128 a[132:135], v113 offset:33792
    v_mfma_f32_16x16x32_bf16 v[20:23], v[60:63], v[160:163], v[20:23]
    ds_read_b64_tr_b16 v[76:77], v15 offset:4096
    s_add_u32 m0, s60, 40960
    ds_read_b128 a[136:139], v113 offset:34816
    v_mfma_f32_16x16x32_bf16 v[24:27], v[60:63], v[164:167], v[24:27]
    ds_read_b64_tr_b16 v[78:79], v15 offset:4608
    s_add_u32 s61, s62, s69
    ds_read_b128 a[140:143], v113 offset:35840
    v_mfma_f32_16x16x32_bf16 v[28:31], v[60:63], v[168:171], v[28:31]
    buffer_load_dwordx4 v12, s[28:31], s61 offen offset:0 lds
    v_cvt_pk_bf16_f32 v97, v54, v55
    v_mfma_f32_16x16x32_bf16 v[32:35], v[60:63], v[172:175], v[32:35]
    ds_read_b128 a[144:147], v113 offset:36864
    ds_read_b128 a[148:151], v113 offset:37888
    v_mfma_f32_16x16x32_bf16 v[16:19], v[64:67], v[176:179], v[16:19]
    v_pk_max_i16 v96, v96, 0
    v_pk_max_i16 v97, v97, 0
    v_mfma_f32_16x16x32_bf16 v[20:23], v[64:67], v[180:183], v[20:23]
    ds_read_b128 a[152:155], v113 offset:38912
    v_mfma_f32_16x16x32_bf16 v[24:27], v[64:67], v[184:187], v[24:27]
    ds_read_b128 a[156:159], v113 offset:39936
    v_mfma_f32_16x16x32_bf16 v[28:31], v[64:67], v[188:191], v[28:31]
    buffer_load_dwordx4 v13, s[28:31], s61 offen offset:1024 lds
    ds_write_b64 v112, v[96:97] offset:4096
    v_mfma_f32_16x16x32_bf16 v[32:35], v[64:67], v[192:195], v[32:35]
    s_waitcnt lgkmcnt(6)
    v_mfma_f32_16x16x32_bf16 v[16:19], v[68:71], v[196:199], v[16:19]
    s_waitcnt vmcnt(6)
    s_barrier
    v_mfma_f32_16x16x32_bf16 v[20:23], v[68:71], v[200:203], v[20:23]
    ds_read_b64_tr_b16 v[56:57], v14 offset:0
    s_add_u32 m0, s60, 49152
    ds_read_b128 a[160:163], v114 offset:0
    v_mfma_f32_16x16x32_bf16 v[24:27], v[68:71], v[204:207], v[24:27]
    ds_read_b64_tr_b16 v[58:59], v14 offset:512
    s_add_u32 s61, s62, s70
    ds_read_b128 a[164:167], v114 offset:1024
    v_mfma_f32_16x16x32_bf16 v[28:31], v[68:71], v[208:211], v[28:31]
    buffer_load_dwordx4 v12, s[28:31], s61 offen offset:0 lds
    v_mfma_f32_16x16x32_bf16 v[32:35], v[68:71], v[212:215], v[32:35]
    ds_read_b64_tr_b16 v[60:61], v14 offset:4096
    ds_read_b128 a[168:171], v114 offset:2048
    v_mfma_f32_16x16x32_bf16 v[16:19], v[72:75], v[216:219], v[16:19]
    ds_read_b64_tr_b16 v[62:63], v14 offset:4608
    ds_read_b128 a[172:175], v114 offset:3072
    v_mfma_f32_16x16x32_bf16 v[20:23], v[72:75], v[220:223], v[20:23]
    ds_read_b64_tr_b16 v[64:65], v14 offset:8192
    ds_read_b128 a[176:179], v114 offset:4096
    v_mfma_f32_16x16x32_bf16 v[24:27], v[72:75], v[224:227], v[24:27]
    ds_read_b64_tr_b16 v[66:67], v14 offset:8704
    ds_read_b128 a[180:183], v114 offset:5120
    v_mfma_f32_16x16x32_bf16 v[28:31], v[72:75], v[228:231], v[28:31]
    buffer_load_dwordx4 v13, s[28:31], s61 offen offset:1024 lds
    v_mfma_f32_16x16x32_bf16 v[32:35], v[72:75], v[232:235], v[32:35]
    ds_read_b128 a[184:187], v114 offset:6144
    ds_read_b128 a[188:191], v114 offset:7168
    v_mfma_f32_16x16x32_bf16 v[36:39], v[76:79], v[236:239], v[16:19]
    v_add_u32 v112, 10240, v112
    v_mfma_f32_16x16x32_bf16 v[40:43], v[76:79], v[240:243], v[20:23]
    s_add_u32 m0, s60, 57344
    ds_read_b128 a[192:195], v114 offset:8192
    v_mfma_f32_16x16x32_bf16 v[44:47], v[76:79], v[244:247], v[24:27]
    s_add_u32 s61, s62, s71
    ds_read_b128 a[196:199], v114 offset:9216
    v_mfma_f32_16x16x32_bf16 v[48:51], v[76:79], v[248:251], v[28:31]
    buffer_load_dwordx4 v12, s[28:31], s61 offen offset:0 lds
    v_mfma_f32_16x16x32_bf16 v[52:55], v[76:79], v[252:255], v[32:35]
    s_waitcnt lgkmcnt(5)
    v_mfma_f32_16x16x32_bf16 v[16:19], a[0:3], v[56:59], 0
    ds_read_b64_tr_b16 v[68:69], v14 offset:12288
    ds_read_b64_tr_b16 v[70:71], v14 offset:12800
    v_mfma_f32_16x16x32_bf16 v[20:23], a[4:7], v[56:59], 0
    ds_read_b64_tr_b16 v[72:73], v14 offset:16384
    v_mfma_f32_16x16x32_bf16 v[24:27], a[8:11], v[56:59], 0
    buffer_load_dwordx4 v13, s[28:31], s61 offen offset:1024 lds
    v_mfma_f32_16x16x32_bf16 v[28:31], a[12:15], v[56:59], 0
    s_add_u32 s62, s62, 128
    s_cmp_eq_u32 s62, 1152
    s_cselect_b32 s62, 0, s62
    s_cmp_eq_u32 s62, s72
    s_cselect_b32 s62, 1073741824, s62
    s_xor_b32 s60, s60, 0x10000
    ds_read_b64_tr_b16 v[74:75], v14 offset:16896
    v_cvt_pk_bf16_f32 v88, v36, v37
    v_mfma_f32_16x16x32_bf16 v[32:35], a[16:19], v[56:59], 0
    s_add_u32 m0, s60, 0
    s_add_u32 s61, s62, s64
    ds_read_b64_tr_b16 v[76:77], v14 offset:20480
    v_cvt_pk_bf16_f32 v89, v38, v39
    v_mfma_f32_16x16x32_bf16 v[16:19], a[20:23], v[60:63], v[16:19]
    buffer_load_dwordx4 v12, s[28:31], s61 offen offset:0 lds
    v_pk_max_i16 v88, v88, 0
    v_mfma_f32_16x16x32_bf16 v[20:23], a[24:27], v[60:63], v[20:23]
    ds_read_b64_tr_b16 v[78:79], v14 offset:20992
    ds_read_b128 a[200:203], v114 offset:10240
    v_pk_max_i16 v89, v89, 0
    v_mfma_f32_16x16x32_bf16 v[24:27], a[28:31], v[60:63], v[24:27]
    ds_read_b128 a[204:207], v114 offset:11264
    v_cvt_pk_bf16_f32 v90, v40, v41
    v_mfma_f32_16x16x32_bf16 v[28:31], a[32:35], v[60:63], v[28:31]
    ds_read_b128 a[208:211], v114 offset:12288
    v_cvt_pk_bf16_f32 v91, v42, v43
    v_mfma_f32_16x16x32_bf16 v[32:35], a[36:39], v[60:63], v[32:35]
    buffer_load_dwordx4 v13, s[28:31], s61 offen offset:1024 lds
    v_pk_max_i16 v90, v90, 0
    v_mfma_f32_16x16x32_bf16 v[16:19], a[40:43], v[64:67], v[16:19]
    ds_read_b128 a[212:215], v114 offset:13312
    v_pk_max_i16 v91, v91, 0
    v_mfma_f32_16x16x32_bf16 v[20:23], a[44:47], v[64:67], v[20:23]
    s_add_u32 m0, s60, 8192
    s_add_u32 s61, s62, s65
    ds_read_b128 a[216:219], v114 offset:14336
    v_mfma_f32_16x16x32_bf16 v[24:27], a[48:51], v[64:67], v[24:27]
    buffer_load_dwordx4 v12, s[28:31], s61 offen offset:0 lds
    ds_write_b64 v112, v[88:89] offset:0
    v_mfma_f32_16x16x32_bf16 v[28:31], a[52:55], v[64:67], v[28:31]
    ds_write_b64 v112, v[90:91] offset:1024
    v_mfma_f32_16x16x32_bf16 v[32:35], a[56:59], v[64:67], v[32:35]
    s_waitcnt lgkmcnt(2)
    v_mfma_f32_16x16x32_bf16 v[16:19], a[60:63], v[68:71], v[16:19]
    s_waitcnt vmcnt(7)
    s_barrier
    v_mfma_f32_16x16x32_bf16 v[20:23], a[64:67], v[68:71], v[20:23]
    ds_read_b64_tr_b16 v[80:81], v14 offset:24576
    ds_read_b64_tr_b16 v[82:83], v14 offset:25088
    v_mfma_f32_16x16x32_bf16 v[24:27], a[68:71], v[68:71], v[24:27]
    buffer_load_dwordx4 v13, s[28:31], s61 offen offset:1024 lds
    v_mfma_f32_16x16x32_bf16 v[28:31], a[72:75], v[68:71], v[28:31]
    ds_read_b64_tr_b16 v[84:85], v14 offset:28672
    ds_read_b64_tr_b16 v[86:87], v14 offset:29184
    v_cvt_pk_bf16_f32 v92, v44, v45
    v_mfma_f32_16x16x32_bf16 v[32:35], a[76:79], v[68:71], v[32:35]
    s_add_u32 m0, s60, 16384
    s_add_u32 s61, s62, s66
    ds_read_b128 a[220:223], v114 offset:15360
    ds_read_b128 a[224:227], v114 offset:16384
    v_cvt_pk_bf16_f32 v93, v46, v47
    v_mfma_f32_16x16x32_bf16 v[16:19], a[80:83], v[72:75], v[16:19]
    buffer_load_dwordx4 v12, s[28:31], s61 offen offset:0 lds
    v_pk_max_i16 v92, v92, 0
    v_mfma_f32_16x16x32_bf16 v[20:23], a[84:87], v[72:75], v[20:23]
    ds_read_b128 a[228:231], v114 offset:17408
    v_pk_max_i16 v93, v93, 0
    v_mfma_f32_16x16x32_bf16 v[24:27], a[88:91], v[72:75], v[24:27]
    ds_read_b128 a[232:235], v114 offset:18432
    ds_read_b128 a[236:239], v114 offset:19456
    v_cvt_pk_bf16_f32 v94, v48, v49
    v_mfma_f32_16x16x32_bf16 v[28:31], a[92:95], v[72:75], v[28:31]
    ds_read_b128 a[240:243], v114 offset:20480
    ds_read_b128 a[244:247], v114 offset:21504
    v_cvt_pk_bf16_f32 v95, v50, v51
    v_mfma_f32_16x16x32_bf16 v[32:35], a[96:99], v[72:75], v[32:35]
    buffer_load_dwordx4 v13, s[28:31], s61 offen offset:1024 lds
    v_pk_max_i16 v94, v94, 0
    v_mfma_f32_16x16x32_bf16 v[16:19], a[100:103], v[76:79], v[16:19]
    ds_read_b128 a[248:251], v114 offset:22528
    ds_read_b128 a[252:255], v114 offset:23552
    v_pk_max_i16 v95, v95, 0
    v_mfma_f32_16x16x32_bf16 v[20:23], a[104:107], v[76:79], v[20:23]
    s_add_u32 m0, s60, 24576
    s_add_u32 s61, s62, s67
    ds_read_b128 v[152:155], v114 offset:24576
    v_mfma_f32_16x16x32_bf16 v[24:27], a[108:111], v[76:79], v[24:27]
    buffer_load_dwordx4 v12, s[28:31], s61 offen offset:0 lds
    ds_write_b64 v112, v[92:93] offset:2048
    v_mfma_f32_16x16x32_bf16 v[28:31], a[112:115], v[76:79], v[28:31]
    ds_write_b64 v112, v[94:95] offset:3072
    v_mfma_f32_16x16x32_bf16 v[32:35], a[116:119], v[76:79], v[32:35]
    s_waitcnt lgkmcnt(2)
    v_mfma_f32_16x16x32_bf16 v[16:19], a[120:123], v[80:83], v[16:19]
    ds_read_b64_tr_b16 v[56:57], v14 offset:32768
    ds_read_b64_tr_b16 v[58:59], v14 offset:33280
    ds_read_b64_tr_b16 v[60:61], v14 offset:36864
    v_mfma_f32_16x16x32_bf16 v[20:23], a[124:127], v[80:83], v[20:23]
    ds_read_b64_tr_b16 v[62:63], v14 offset:37376
    ds_read_b64_tr_b16 v[64:65], v14 offset:40960
    ds_read_b64_tr_b16 v[66:67], v14 offset:41472
    v_mfma_f32_16x16x32_bf16 v[24:27], a[128:131], v[80:83], v[24:27]
    buffer_load_dwordx4 v13, s[28:31], s61 offen offset:1024 lds
    v_mfma_f32_16x16x32_bf16 v[28:31], a[132:135], v[80:83], v[28:31]
    ds_read_b64_tr_b16 v[68:69], v14 offset:45056
    ds_read_b64_tr_b16 v[70:71], v14 offset:45568
    v_cvt_pk_bf16_f32 v96, v52, v53
    v_mfma_f32_16x16x32_bf16 v[32:35], a[136:139], v[80:83], v[32:35]
    s_add_u32 m0, s60, 32768
    s_add_u32 s61, s62, s68
    ds_read_b128 v[156:159], v114 offset:25600
    ds_read_b128 v[160:163], v114 offset:26624
    ds_read_b128 v[164:167], v114 offset:27648
    v_cvt_pk_bf16_f32 v97, v54, v55
    v_mfma_f32_16x16x32_bf16 v[16:19], a[140:143], v[84:87], v[16:19]
    buffer_load_dwordx4 v12, s[28:31], s61 offen offset:0 lds
    v_pk_max_i16 v96, v96, 0
    v_mfma_f32_16x16x32_bf16 v[20:23], a[144:147], v[84:87], v[20:23]
    ds_read_b128 v[168:171], v114 offset:28672
    ds_read_b128 v[172:175], v114 offset:29696
    v_pk_max_i16 v97, v97, 0
    v_mfma_f32_16x16x32_bf16 v[24:27], a[148:151], v[84:87], v[24:27]
    ds_write_b64 v112, v[96:97] offset:4096
    v_mfma_f32_16x16x32_bf16 v[28:31], a[152:155], v[84:87], v[28:31]
    buffer_load_dwordx4 v13, s[28:31], s61 offen offset:1024 lds
    v_mfma_f32_16x16x32_bf16 v[32:35], a[156:159], v[84:87], v[32:35]
    s_waitcnt lgkmcnt(1)
    v_mfma_f32_16x16x32_bf16 v[16:19], a[160:163], v[56:59], v[16:19]
    s_waitcnt vmcnt(10) lgkmcnt(0)
    s_barrier
    v_mfma_f32_16x16x32_bf16 v[20:23], a[164:167], v[56:59], v[20:23]
    s_add_u32 m0, s60, 40960
    s_add_u32 s61, s62, s69
    ds_read_b64_tr_b16 v[72:73], v14 offset:49152
    ds_read_b64_tr_b16 v[74:75], v14 offset:49664
    v_sub_u32 v5, s6, v1
    v_add_u32 v6, 9, v5
    v_mfma_f32_16x16x32_bf16 v[24:27], a[168:171], v[56:59], v[24:27]
    buffer_load_dwordx4 v12, s[28:31], s61 offen offset:0 lds
    v_min_u32 v5, v5, v6
    v_mfma_f32_16x16x32_bf16 v[28:31], a[172:175], v[56:59], v[28:31]
    ds_read_b64_tr_b16 v[76:77], v14 offset:53248
    v_lshl_add_u32 v5, v5, 3, v1
    v_mfma_f32_16x16x32_bf16 v[32:35], a[176:179], v[56:59], v[32:35]
    ds_read_b64_tr_b16 v[78:79], v14 offset:53760
    ds_read_b64_tr_b16 v[80:81], v14 offset:57344
    s_mul_i32 s95, s4, 1032192
    v_mfma_f32_16x16x32_bf16 v[16:19], a[180:183], v[60:63], v[16:19]
    buffer_load_dwordx4 v13, s[28:31], s61 offen offset:1024 lds
    s_mul_i32 s96, s3, 3584
    v_mfma_f32_16x16x32_bf16 v[20:23], a[184:187], v[60:63], v[20:23]
    ds_read_b64_tr_b16 v[82:83], v14 offset:57856
    s_add_u32 s95, s95, s96
    v_mfma_f32_16x16x32_bf16 v[24:27], a[188:191], v[60:63], v[24:27]
    ds_read_b64_tr_b16 v[84:85], v14 offset:61440
    ds_read_b64_tr_b16 v[86:87], v14 offset:61952
    s_add_u32 s95, s95, 4194304
    v_mfma_f32_16x16x32_bf16 v[28:31], a[192:195], v[60:63], v[28:31]
    s_add_u32 m0, s60, 49152
    s_add_u32 s61, s62, s70
    ds_read_b128 v[176:179], v114 offset:30720
    v_mul_u32_u24 v5, 14336, v5
    v_mfma_f32_16x16x32_bf16 v[32:35], a[196:199], v[60:63], v[32:35]
    buffer_load_dwordx4 v12, s[28:31], s61 offen offset:0 lds
    s_add_u32 s97, s95, 2560
    v_mfma_f32_16x16x32_bf16 v[16:19], a[200:203], v[64:67], v[16:19]
    ds_read_b128 v[180:183], v114 offset:31744
    ds_read_b128 v[184:187], v114 offset:32768
    v_add_u32 v5, s97, v5
    s_lshl_b32 s97, s4, 7
    v_mfma_f32_16x16x32_bf16 v[20:23], a[204:207], v[64:67], v[20:23]
    ds_read_b128 v[188:191], v114 offset:33792
    s_add_u32 s97, s97, 40928
    v_mfma_f32_16x16x32_bf16 v[24:27], a[208:211], v[64:67], v[24:27]
    ds_read_b128 v[192:195], v114 offset:34816
    ds_read_b128 v[196:199], v114 offset:35840
    v_lshl_add_u32 v6, v1, 2, s97
    v_mfma_f32_16x16x32_bf16 v[28:31], a[212:215], v[64:67], v[28:31]
    buffer_load_dwordx4 v13, s[28:31], s61 offen offset:1024 lds
    v_cmp_gt_u32 vcc, 8, v1
    v_mfma_f32_16x16x32_bf16 v[32:35], a[216:219], v[64:67], v[32:35]
    ds_read_b128 v[200:203], v114 offset:36864
    s_mov_b32 s82, 268435232
    v_mfma_f32_16x16x32_bf16 v[16:19], a[220:223], v[68:71], v[16:19]
    ds_read_b128 v[204:207], v114 offset:37888
    ds_read_b128 v[208:211], v114 offset:38912
    s_mul_i32 s97, s6, 114688
    v_mfma_f32_16x16x32_bf16 v[20:23], a[224:227], v[68:71], v[20:23]
    s_add_u32 m0, s60, 57344
    s_add_u32 s61, s62, s71
    ds_read_b128 v[212:215], v114 offset:39936
    v_cndmask_b32 v5, v6, v5, vcc
    v_mfma_f32_16x16x32_bf16 v[24:27], a[228:231], v[68:71], v[24:27]
    buffer_load_dwordx4 v12, s[28:31], s61 offen offset:0 lds
    s_mov_b32 s83, 0
    v_mfma_f32_16x16x32_bf16 v[28:31], a[232:235], v[68:71], v[28:31]
    v_mov_b32 v6, 1073741824
    v_mfma_f32_16x16x32_bf16 v[32:35], a[236:239], v[68:71], v[32:35]
    s_waitcnt lgkmcnt(0)
    v_mfma_f32_16x16x32_bf16 v[16:19], a[240:243], v[72:75], v[16:19]
    s_waitcnt vmcnt(7)
    s_barrier
    v_xor_b32 v14, 0x10000, v14
    v_mfma_f32_16x16x32_bf16 v[20:23], a[244:247], v[72:75], v[20:23]
    ds_read_b64_tr_b16 v[56:57], v14 offset:0
    s_add_u32 s95, s95, s97
    v_cndmask_b32 v127, v6, v5, s[82:83]
    s_mov_b32 s82, 192
    v_mfma_f32_16x16x32_bf16 v[24:27], a[248:251], v[72:75], v[24:27]
    buffer_load_dwordx4 v13, s[28:31], s61 offen offset:1024 lds
    s_add_u32 s95, s95, 0
    v_cndmask_b32 v255, v6, v5, s[82:83]
    s_mov_b32 s82, 31
    v_mfma_f32_16x16x32_bf16 v[28:31], a[252:255], v[72:75], v[28:31]
    s_add_u32 s62, s62, 128
    s_cmp_eq_u32 s62, 1152
    s_cselect_b32 s62, 0, s62
    s_cmp_eq_u32 s62, s72
    s_cselect_b32 s62, 1073741824, s62
    s_xor_b32 s60, s60, 0x10000
    ds_read_b64_tr_b16 v[58:59], v14 offset:512
    s_nop 0
    v_cndmask_b32 v129, v6, v5, s[82:83]
    v_mfma_f32_16x16x32_bf16 v[32:35], v[152:155], v[72:75], v[32:35]
    s_add_u32 m0, s60, 0
    s_add_u32 s61, s62, s64
    s_add_u32 s96, s6, 2
    s_mov_b32 s63, 7
    s_mov_b32 s34, 1073741824
    v_mfma_f32_16x16x32_bf16 v[16:19], v[156:159], v[76:79], v[16:19]
    buffer_load_dwordx4 v12, s[28:31], s61 offen offset:0 lds
    s_mov_b32 s35, 0
    v_lshlrev_b32 v4, 2, v1
    v_cmp_gt_u32 vcc, 32, v1
    v_mfma_f32_16x16x32_bf16 v[20:23], v[160:163], v[76:79], v[20:23]
    ds_read_b64_tr_b16 v[60:61], v14 offset:4096
    v_lshlrev_b32 v5, 2, v3
    v_sub_u32 v5, v2, v5
    v_mfma_f32_16x16x32_bf16 v[24:27], v[164:167], v[76:79], v[24:27]
    ds_read_b64_tr_b16 v[62:63], v14 offset:4608
    v_cndmask_b32 v254, v6, v4, vcc
    v_and_b32 v4, 1, v5
    v_lshlrev_b32 v4, 4, v4
    v_mfma_f32_16x16x32_bf16 v[28:31], v[168:171], v[76:79], v[28:31]
    v_mov_b32 v6, 0x3f80
    v_lshlrev_b32 v4, v4, v6
    v_mfma_f32_16x16x32_bf16 v[32:35], v[172:175], v[76:79], v[32:35]
    buffer_load_dwordx4 v13, s[28:31], s61 offen offset:1024 lds
    v_lshrrev_b32 v5, 1, v5
    v_cmp_eq_u32 vcc, 0, v5
    v_mov_b32 v248, 0
    v_mfma_f32_16x16x32_bf16 v[16:19], v[176:179], v[80:83], v[16:19]
    ds_read_b64_tr_b16 v[64:65], v14 offset:8192
    v_mov_b32 v249, 0
    v_cndmask_b32 v250, 0, v4, vcc
    v_cmp_eq_u32 vcc, 1, v5
    v_mfma_f32_16x16x32_bf16 v[20:23], v[180:183], v[80:83], v[20:23]
    ds_read_b64_tr_b16 v[66:67], v14 offset:8704
    v_mov_b32 v252, 0
    v_mov_b32 v253, 0
    v_mfma_f32_16x16x32_bf16 v[24:27], v[184:187], v[80:83], v[24:27]
    s_add_u32 m0, s60, 8192
    s_add_u32 s61, s62, s65
    v_cndmask_b32 v251, 0, v4, vcc
    v_mov_b32 v246, 0
    v_mov_b32 v247, 0
    v_mfma_f32_16x16x32_bf16 v[28:31], v[188:191], v[80:83], v[28:31]
    buffer_load_dwordx4 v12, s[28:31], s61 offen offset:0 lds
    s_mov_b32 s35, 7
    s_mul_i32 s99, s4, 21846
    v_mfma_f32_16x16x32_bf16 v[32:35], v[192:195], v[80:83], v[32:35]
    ds_read_b64_tr_b16 v[68:69], v14 offset:12288
    s_lshr_b32 s99, s99, 16
    s_mul_i32 s99, s99, 3
    s_sub_u32 s99, s4, s99
    v_mfma_f32_16x16x32_bf16 v[36:39], v[196:199], v[84:87], v[16:19]
    ds_read_b64_tr_b16 v[70:71], v14 offset:12800
    s_min_u32 s99, s99, 2
    s_lshl_b32 s99, 2, s99
    s_mov_b32 s94, s95
    v_mfma_f32_16x16x32_bf16 v[40:43], v[200:203], v[84:87], v[20:23]
    s_and_b32 s99, s4, 1
    s_lshl_b32 s99, 4, s99
    v_mfma_f32_16x16x32_bf16 v[44:47], v[204:207], v[84:87], v[24:27]
    buffer_load_dwordx4 v13, s[28:31], s61 offen offset:1024 lds
    s_or_b32 s99, s99, 2
    s_cmp_lt_u32 s6, 3
    s_cselect_b32 s100, 1032192, 0
    s_add_u32 s100, s100, s95
    s_sub_u32 s100, s100, 301056
    s_cmp_lt_u32 s6, 4
    s_cselect_b32 s101, 1032192, 0
    s_add_u32 s101, s101, s95
    s_sub_u32 s101, s101, 401408
    v_mfma_f32_16x16x32_bf16 v[48:51], v[208:211], v[84:87], v[28:31]
    s_cmp_lt_u32 s6, 1
    s_cselect_b32 s96, 1032192, 0
    s_add_u32 s96, s96, s95
    s_sub_u32 s96, s96, 100352
    s_cmp_lt_u32 s6, 2
    s_cselect_b32 s34, 1032192, 0
    s_add_u32 s34, s34, s95
    s_sub_u32 s34, s34, 200704
    v_mfma_f32_16x16x32_bf16 v[52:55], v[212:215], v[84:87], v[32:35]
    s_waitcnt lgkmcnt(0)
L_g2:
    v_mfma_f32_16x16x32_bf16 v[16:19], a[0:3], v[56:59], 0
    s_bitcmp1_b32 s99, s63
    s_cbranch_scc1 L_ep0
L_ep0_ret:
    v_mfma_f32_16x16x32_bf16 v[20:23], a[4:7], v[56:59], 0
    s_add_u32 m0, s60, 16384
    ds_read_b64_tr_b16 v[72:73], v14 offset:16384
    v_mfma_f32_16x16x32_bf16 v[24:27], a[8:11], v[56:59], 0
    s_add_u32 s61, s62, s66
    ds_read_b64_tr_b16 v[74:75], v14 offset:16896
    v_mfma_f32_16x16x32_bf16 v[28:31], a[12:15], v[56:59], 0
    buffer_load_dwordx4 v12, s[28:31], s61 offen offset:0 lds
    v_cvt_pk_bf16_f32 v88, v36, v37
    v_mfma_f32_16x16x32_bf16 v[32:35], a[16:19], v[56:59], 0
    ds_read_b64_tr_b16 v[76:77], v14 offset:20480
    v_cvt_pk_bf16_f32 v89, v38, v39
    v_cvt_pk_bf16_f32 v90, v40, v41
    v_mfma_f32_16x16x32_bf16 v[16:19], a[20:23], v[60:63], v[16:19]
    ds_read_b64_tr_b16 v[78:79], v14 offset:20992
    v_cvt_pk_bf16_f32 v91, v42, v43
    v_mfma_f32_16x16x32_bf16 v[20:23], a[24:27], v[60:63], v[20:23]
    buffer_store_dwordx4 v[88:91], v124, s[16:19], s78 offen sc1
    v_mfma_f32_16x16x32_bf16 v[24:27], a[28:31], v[60:63], v[24:27]
    ds_read_b64_tr_b16 v[80:81], v14 offset:24576
    v_cvt_pk_bf16_f32 v92, v44, v45
    v_mfma_f32_16x16x32_bf16 v[28:31], a[32:35], v[60:63], v[28:31]
    buffer_load_dwordx4 v13, s[28:31], s61 offen offset:1024 lds
    v_cvt_pk_bf16_f32 v93, v46, v47
    v_mfma_f32_16x16x32_bf16 v[32:35], a[36:39], v[60:63], v[32:35]
    ds_read_b64_tr_b16 v[82:83], v14 offset:25088
    v_cvt_pk_bf16_f32 v94, v48, v49
    v_cvt_pk_bf16_f32 v95, v50, v51
    v_mfma_f32_16x16x32_bf16 v[16:19], a[40:43], v[64:67], v[16:19]
    buffer_store_dwordx4 v[92:95], v124, s[16:19], s78 offen offset:1024 sc1
    v_mfma_f32_16x16x32_bf16 v[20:23], a[44:47], v[64:67], v[20:23]
    s_add_u32 m0, s60, 24576
    ds_read_b64_tr_b16 v[84:85], v14 offset:28672
    v_mfma_f32_16x16x32_bf16 v[24:27], a[48:51], v[64:67], v[24:27]
    s_add_u32 s61, s62, s67
    ds_read_b64_tr_b16 v[86:87], v14 offset:29184
    v_mfma_f32_16x16x32_bf16 v[28:31], a[52:55], v[64:67], v[28:31]
    buffer_load_dwordx4 v12, s[28:31], s61 offen offset:0 lds
    v_cvt_pk_bf16_f32 v96, v52, v53
    v_mfma_f32_16x16x32_bf16 v[32:35], a[56:59], v[64:67], v[32:35]
    v_cvt_pk_bf16_f32 v97, v54, v55
    v_mfma_f32_16x16x32_bf16 v[16:19], a[60:63], v[68:71], v[16:19]
    buffer_store_dwordx2 v[96:97], v125, s[16:19], s78 offen offset:2048 sc1
    v_mfma_f32_16x16x32_bf16 v[20:23], a[64:67], v[68:71], v[20:23]
    v_mfma_f32_16x16x32_bf16 v[24:27], a[68:71], v[68:71], v[24:27]
    v_mfma_f32_16x16x32_bf16 v[28:31], a[72:75], v[68:71], v[28:31]
    buffer_load_dwordx4 v13, s[28:31], s61 offen offset:1024 lds
    v_mfma_f32_16x16x32_bf16 v[32:35], a[76:79], v[68:71], v[32:35]
    s_waitcnt lgkmcnt(0)
    v_mfma_f32_16x16x32_bf16 v[16:19], a[80:83], v[72:75], v[16:19]
    s_waitcnt vmcnt(11)
    s_barrier
    v_mfma_f32_16x16x32_bf16 v[20:23], a[84:87], v[72:75], v[20:23]
    ds_read_b64_tr_b16 v[56:57], v14 offset:32768
    s_add_u32 m0, s60, 32768
    v_mfma_f32_16x16x32_bf16 v[24:27], a[88:91], v[72:75], v[24:27]
    ds_read_b64_tr_b16 v[58:59], v14 offset:33280
    s_add_u32 s61, s62, s68
    v_mfma_f32_16x16x32_bf16 v[28:31], a[92:95], v[72:75], v[28:31]
    buffer_load_dwordx4 v12, s[28:31], s61 offen offset:0 lds
    v_mfma_f32_16x16x32_bf16 v[32:35], a[96:99], v[72:75], v[32:35]
    ds_read_b64_tr_b16 v[60:61], v14 offset:36864
    v_mfma_f32_16x16x32_bf16 v[16:19], a[100:103], v[76:79], v[16:19]
    ds_read_b64_tr_b16 v[62:63], v14 offset:37376
    v_mfma_f32_16x16x32_bf16 v[20:23], a[104:107], v[76:79], v[20:23]
    ds_read_b64_tr_b16 v[64:65], v14 offset:40960
    v_mfma_f32_16x16x32_bf16 v[24:27], a[108:111], v[76:79], v[24:27]
    ds_read_b64_tr_b16 v[66:67], v14 offset:41472
    v_mfma_f32_16x16x32_bf16 v[28:31], a[112:115], v[76:79], v[28:31]
    buffer_load_dwordx4 v13, s[28:31], s61 offen offset:1024 lds
    v_mfma_f32_16x16x32_bf16 v[32:35], a[116:119], v[76:79], v[32:35]
    ds_read_b64_tr_b16 v[68:69], v14 offset:45056
    v_mfma_f32_16x16x32_bf16 v[16:19], a[120:123], v[80:83], v[16:19]
    ds_read_b64_tr_b16 v[70:71], v14 offset:45568
    v_mfma_f32_16x16x32_bf16 v[20:23], a[124:127], v[80:83], v[20:23]
    s_add_u32 m0, s60, 40960
    v_mfma_f32_16x16x32_bf16 v[24:27], a[128:131], v[80:83], v[24:27]
    s_add_u32 s61, s62, s69
    v_mfma_f32_16x16x32_bf16 v[28:31], a[132:135], v[80:83], v[28:31]
    buffer_load_dwordx4 v12, s[28:31], s61 offen offset:0 lds
    v_mfma_f32_16x16x32_bf16 v[32:35], a[136:139], v[80:83], v[32:35]
    v_mfma_f32_16x16x32_bf16 v[16:19], a[140:143], v[84:87], v[16:19]
    v_mfma_f32_16x16x32_bf16 v[20:23], a[144:147], v[84:87], v[20:23]
    v_mfma_f32_16x16x32_bf16 v[24:27], a[148:151], v[84:87], v[24:27]
    v_mfma_f32_16x16x32_bf16 v[28:31], a[152:155], v[84:87], v[28:31]
    buffer_load_dwordx4 v13, s[28:31], s61 offen offset:1024 lds
    v_mfma_f32_16x16x32_bf16 v[32:35], a[156:159], v[84:87], v[32:35]
    s_waitcnt lgkmcnt(0)
    v_mfma_f32_16x16x32_bf16 v[16:19], a[160:163], v[56:59], v[16:19]
    v_mfma_f32_16x16x32_bf16 v[20:23], a[164:167], v[56:59], v[20:23]
    ds_read_b64_tr_b16 v[72:73], v14 offset:49152
    s_add_u32 m0, s60, 49152
    v_mfma_f32_16x16x32_bf16 v[24:27], a[168:171], v[56:59], v[24:27]
    ds_read_b64_tr_b16 v[74:75], v14 offset:49664
    s_add_u32 s61, s62, s70
    v_mfma_f32_16x16x32_bf16 v[28:31], a[172:175], v[56:59], v[28:31]
    buffer_load_dwordx4 v12, s[28:31], s61 offen offset:0 lds
    v_mfma_f32_16x16x32_bf16 v[32:35], a[176:179], v[56:59], v[32:35]
    ds_read_b64_tr_b16 v[76:77], v14 offset:53248
    v_mfma_f32_16x16x32_bf16 v[16:19], a[180:183], v[60:63], v[16:19]
    ds_read_b64_tr_b16 v[78:79], v14 offset:53760
    v_mfma_f32_16x16x32_bf16 v[20:23], a[184:187], v[60:63], v[20:23]
    ds_read_b64_tr_b16 v[80:81], v14 offset:57344
    v_mfma_f32_16x16x32_bf16 v[24:27], a[188:191], v[60:63], v[24:27]
    ds_read_b64_tr_b16 v[82:83], v14 offset:57856
    v_mfma_f32_16x16x32_bf16 v[28:31], a[192:195], v[60:63], v[28:31]
    buffer_load_dwordx4 v13, s[28:31], s61 offen offset:1024 lds
    v_mfma_f32_16x16x32_bf16 v[32:35], a[196:199], v[60:63], v[32:35]
    ds_read_b64_tr_b16 v[84:85], v14 offset:61440
    v_mfma_f32_16x16x32_bf16 v[16:19], a[200:203], v[64:67], v[16:19]
    ds_read_b64_tr_b16 v[86:87], v14 offset:61952
    v_mfma_f32_16x16x32_bf16 v[20:23], a[204:207], v[64:67], v[20:23]
    s_add_u32 m0, s60, 57344
    v_mfma_f32_16x16x32_bf16 v[24:27], a[208:211], v[64:67], v[24:27]
    s_add_u32 s61, s62, s71
    v_mfma_f32_16x16x32_bf16 v[28:31], a[212:215], v[64:67], v[28:31]
    buffer_load_dwordx4 v12, s[28:31], s61 offen offset:0 lds
    v_mfma_f32_16x16x32_bf16 v[32:35], a[216:219], v[64:67], v[32:35]
    s_add_u32 s62, s62, 128
    s_xor_b32 s60, s60, 0x10000
    v_mfma_f32_16x16x32_bf16 v[16:19], a[220:223], v[68:71], v[16:19]
    s_cmp_eq_u32 s62, 1152
    s_cselect_b32 s62, 0, s62
    v_mfma_f32_16x16x32_bf16 v[20:23], a[224:227], v[68:71], v[20:23]
    s_cmp_eq_u32 s62, s72
    s_cselect_b32 s62, 1073741824, s62
    v_mfma_f32_16x16x32_bf16 v[24:27], a[228:231], v[68:71], v[24:27]
    v_mfma_f32_16x16x32_bf16 v[28:31], a[232:235], v[68:71], v[28:31]
    buffer_load_dwordx4 v13, s[28:31], s61 offen offset:1024 lds
    v_mfma_f32_16x16x32_bf16 v[32:35], a[236:239], v[68:71], v[32:35]
    s_waitcnt lgkmcnt(0)
    v_mfma_f32_16x16x32_bf16 v[16:19], a[240:243], v[72:75], v[16:19]
    s_waitcnt vmcnt(8)
    s_barrier
    v_xor_b32 v14, 0x10000, v14
    v_mfma_f32_16x16x32_bf16 v[20:23], a[244:247], v[72:75], v[20:23]
    ds_read_b64_tr_b16 v[56:57], v14 offset:0
    s_add_u32 m0, s60, 0
    v_mfma_f32_16x16x32_bf16 v[24:27], a[248:251], v[72:75], v[24:27]
    ds_read_b64_tr_b16 v[58:59], v14 offset:512
    s_add_u32 s61, s62, s64
    v_mfma_f32_16x16x32_bf16 v[28:31], a[252:255], v[72:75], v[28:31]
    buffer_load_dwordx4 v12, s[28:31], s61 offen offset:0 lds
    v_mfma_f32_16x16x32_bf16 v[32:35], v[152:155], v[72:75], v[32:35]
    ds_read_b64_tr_b16 v[60:61], v14 offset:4096
    buffer_store_dword v123, v254, s[16:19], s78 offen offset:2560 sc1
    v_mfma_f32_16x16x32_bf16 v[16:19], v[156:159], v[76:79], v[16:19]
    ds_read_b64_tr_b16 v[62:63], v14 offset:4608
    s_bitcmp1_b32 s99, s63
    s_cbranch_scc1 L_ep1
L_ep1_ret:
    v_mfma_f32_16x16x32_bf16 v[20:23], v[160:163], v[76:79], v[20:23]
    ds_read_b64_tr_b16 v[64:65], v14 offset:8192
    v_mfma_f32_16x16x32_bf16 v[24:27], v[164:167], v[76:79], v[24:27]
    ds_read_b64_tr_b16 v[66:67], v14 offset:8704
    v_mfma_f32_16x16x32_bf16 v[28:31], v[168:171], v[76:79], v[28:31]
    buffer_load_dwordx4 v13, s[28:31], s61 offen offset:1024 lds
    v_mfma_f32_16x16x32_bf16 v[32:35], v[172:175], v[76:79], v[32:35]
    ds_read_b64_tr_b16 v[68:69], v14 offset:12288
    v_mfma_f32_16x16x32_bf16 v[16:19], v[176:179], v[80:83], v[16:19]
    ds_read_b64_tr_b16 v[70:71], v14 offset:12800
    v_mfma_f32_16x16x32_bf16 v[20:23], v[180:183], v[80:83], v[20:23]
    s_add_u32 m0, s60, 8192
    v_mfma_f32_16x16x32_bf16 v[24:27], v[184:187], v[80:83], v[24:27]
    s_add_u32 s61, s62, s65
    v_mfma_f32_16x16x32_bf16 v[28:31], v[188:191], v[80:83], v[28:31]
    buffer_load_dwordx4 v12, s[28:31], s61 offen offset:0 lds
    v_mfma_f32_16x16x32_bf16 v[32:35], v[192:195], v[80:83], v[32:35]
    v_mfma_f32_16x16x32_bf16 v[36:39], v[196:199], v[84:87], v[16:19]
    v_mfma_f32_16x16x32_bf16 v[40:43], v[200:203], v[84:87], v[20:23]
    s_add_u32 s78, s78, 14336
    v_mfma_f32_16x16x32_bf16 v[44:47], v[204:207], v[84:87], v[24:27]
    s_sub_u32 s63, s63, 1
    s_cmp_lg_u32 s63, 0
    v_mfma_f32_16x16x32_bf16 v[48:51], v[208:211], v[84:87], v[28:31]
    buffer_load_dwordx4 v13, s[28:31], s61 offen offset:1024 lds
    v_mfma_f32_16x16x32_bf16 v[52:55], v[212:215], v[84:87], v[32:35]
    s_waitcnt lgkmcnt(0)
    s_cbranch_scc1 L_g2
    v_mfma_f32_16x16x32_bf16 v[16:19], a[0:3], v[56:59], 0
    buffer_load_dword v128, v127, s[16:19], 0 offen sc1
    v_mfma_f32_16x16x32_bf16 v[20:23], a[4:7], v[56:59], 0
    v_cvt_pk_bf16_f32 v88, v36, v37
    v_cvt_pk_bf16_f32 v89, v38, v39
    v_mfma_f32_16x16x32_bf16 v[24:27], a[8:11], v[56:59], 0
    v_cvt_pk_bf16_f32 v90, v40, v41
    v_cvt_pk_bf16_f32 v91, v42, v43
    v_mfma_f32_16x16x32_bf16 v[28:31], a[12:15], v[56:59], 0
    buffer_store_dwordx4 v[88:91], v124, s[16:19], s78 offen sc1
    v_mfma_f32_16x16x32_bf16 v[32:35], a[16:19], v[56:59], 0
    v_cvt_pk_bf16_f32 v92, v44, v45
    v_cvt_pk_bf16_f32 v93, v46, v47
    v_mfma_f32_16x16x32_bf16 v[16:19], a[20:23], v[60:63], v[16:19]
    v_cvt_pk_bf16_f32 v94, v48, v49
    v_cvt_pk_bf16_f32 v95, v50, v51
    v_mfma_f32_16x16x32_bf16 v[20:23], a[24:27], v[60:63], v[20:23]
    buffer_store_dwordx4 v[92:95], v124, s[16:19], s78 offen offset:1024 sc1
    v_mfma_f32_16x16x32_bf16 v[24:27], a[28:31], v[60:63], v[24:27]
    v_cvt_pk_bf16_f32 v96, v52, v53
    v_cvt_pk_bf16_f32 v97, v54, v55
    v_mfma_f32_16x16x32_bf16 v[28:31], a[32:35], v[60:63], v[28:31]
    buffer_store_dwordx2 v[96:97], v125, s[16:19], s78 offen offset:2048 sc1
    v_mfma_f32_16x16x32_bf16 v[32:35], a[36:39], v[60:63], v[32:35]
    v_mfma_f32_16x16x32_bf16 v[16:19], a[40:43], v[64:67], v[16:19]
    ds_read_b64_tr_b16 v[72:73], v14 offset:16384
    s_cmp_lt_u32 s6, 0
    s_cselect_b32 s64, 1032192, 0
    s_add_u32 s64, s64, s95
    s_sub_u32 s95, s95, 100352
    v_mfma_f32_16x16x32_bf16 v[20:23], a[44:47], v[64:67], v[20:23]
    ds_read_b64_tr_b16 v[74:75], v14 offset:16896
    s_cmp_lt_u32 s6, 1
    s_cselect_b32 s65, 1032192, 0
    s_add_u32 s65, s65, s95
    s_sub_u32 s95, s95, 100352
    v_mfma_f32_16x16x32_bf16 v[24:27], a[48:51], v[64:67], v[24:27]
    ds_read_b64_tr_b16 v[76:77], v14 offset:20480
    s_cmp_lt_u32 s6, 2
    s_cselect_b32 s66, 1032192, 0
    s_add_u32 s66, s66, s95
    s_sub_u32 s95, s95, 100352
    v_mfma_f32_16x16x32_bf16 v[28:31], a[52:55], v[64:67], v[28:31]
    ds_read_b64_tr_b16 v[78:79], v14 offset:20992
    s_cmp_lt_u32 s6, 3
    s_cselect_b32 s67, 1032192, 0
    s_add_u32 s67, s67, s95
    s_sub_u32 s95, s95, 100352
    v_mfma_f32_16x16x32_bf16 v[32:35], a[56:59], v[64:67], v[32:35]
    ds_read_b64_tr_b16 v[80:81], v14 offset:24576
    s_cmp_lt_u32 s6, 4
    s_cselect_b32 s68, 1032192, 0
    s_add_u32 s68, s68, s95
    s_sub_u32 s95, s95, 100352
    v_mfma_f32_16x16x32_bf16 v[16:19], a[60:63], v[68:71], v[16:19]
    ds_read_b64_tr_b16 v[82:83], v14 offset:25088
    s_cmp_lt_u32 s6, 5
    s_cselect_b32 s69, 1032192, 0
    s_add_u32 s69, s69, s95
    s_sub_u32 s95, s95, 100352
    v_mfma_f32_16x16x32_bf16 v[20:23], a[64:67], v[68:71], v[20:23]
    ds_read_b64_tr_b16 v[84:85], v14 offset:28672
    s_cmp_lt_u32 s6, 6
    s_cselect_b32 s70, 1032192, 0
    s_add_u32 s70, s70, s95
    s_sub_u32 s95, s95, 100352
    v_mfma_f32_16x16x32_bf16 v[24:27], a[68:71], v[68:71], v[24:27]
    ds_read_b64_tr_b16 v[86:87], v14 offset:29184
    s_cmp_lt_u32 s6, 7
    s_cselect_b32 s71, 1032192, 0
    s_add_u32 s71, s71, s95
    s_sub_u32 s95, s95, 100352
    v_mfma_f32_16x16x32_bf16 v[28:31], a[72:75], v[68:71], v[28:31]
    v_mfma_f32_16x16x32_bf16 v[32:35], a[76:79], v[68:71], v[32:35]
    s_mov_b32 s35, 268435232
    s_waitcnt lgkmcnt(0)
    v_mfma_f32_16x16x32_bf16 v[16:19], a[80:83], v[72:75], v[16:19]
    s_waitcnt vmcnt(15)
    s_barrier
    v_mfma_f32_16x16x32_bf16 v[20:23], a[84:87], v[72:75], v[20:23]
    ds_read_b64_tr_b16 v[56:57], v14 offset:32768
    s_lshl_b32 s62, s6, 6
    s_lshl_b32 s94, s3, 4
    s_add_u32 s62, s62, s94
    v_mfma_f32_16x16x32_bf16 v[24:27], a[88:91], v[72:75], v[24:27]
    ds_read_b64_tr_b16 v[58:59], v14 offset:33280
    v_add_u32 v5, s62, v2
    v_sub_u32 v6, 576, v5
    v_mfma_f32_16x16x32_bf16 v[28:31], a[92:95], v[72:75], v[28:31]
    v_cmp_lt_u32 s[76:77], v6, v5
    v_min_u32 v6, v5, v6
    v_mfma_f32_16x16x32_bf16 v[32:35], a[96:99], v[72:75], v[32:35]
    ds_read_b64_tr_b16 v[60:61], v14 offset:36864
    s_mul_i32 s94, s4, 20
    v_add_u32 v7, s94, v3
    v_mfma_f32_16x16x32_bf16 v[16:19], a[100:103], v[76:79], v[16:19]
    ds_read_b64_tr_b16 v[62:63], v14 offset:37376
    s_movk_i32 s34, 2560
    v_lshlrev_b32 v6, 3, v6
    v_mfma_f32_16x16x32_bf16 v[20:23], a[104:107], v[76:79], v[20:23]
    ds_read_b64_tr_b16 v[64:65], v14 offset:40960
    v_mad_u32_u24 v120, v7, s34, v6
    v_add_u32 v120, 2621440, v120
    v_cmp_eq_u32 s[80:81], 0, v7
    v_mfma_f32_16x16x32_bf16 v[24:27], a[108:111], v[76:79], v[24:27]
    ds_read_b64_tr_b16 v[66:67], v14 offset:41472
    v_add_u32 v9, 1310720, v120
    s_and_b64 s[82:83], s[80:81], s[76:77]
    v_mfma_f32_16x16x32_bf16 v[28:31], a[112:115], v[76:79], v[28:31]
    v_lshlrev_b32 v122, 4, v7
    v_add_u32 v122, 65536, v122
    v_mfma_f32_16x16x32_bf16 v[32:35], a[116:119], v[76:79], v[32:35]
    ds_read_b64_tr_b16 v[68:69], v14 offset:45056
    v_cndmask_b32 v121, v120, v9, s[82:83]
    v_mov_b32 v8, 16780300
    v_mfma_f32_16x16x32_bf16 v[16:19], a[120:123], v[80:83], v[16:19]
    ds_read_b64_tr_b16 v[70:71], v14 offset:45568
    v_mov_b32 v9, 117836812
    v_cndmask_b32 v110, v8, v9, s[76:77]
    v_mfma_f32_16x16x32_bf16 v[20:23], a[124:127], v[80:83], v[20:23]
    v_mov_b32 v8, 50465804
    v_mov_b32 v9, 84151308
    v_mfma_f32_16x16x32_bf16 v[24:27], a[128:131], v[80:83], v[24:27]
    s_waitcnt vmcnt(3)
    v_cmp_eq_u32 vcc, s7, v128
    s_and_b32 s97, vcc_lo, s35
    s_cmp_eq_u32 s97, s35
    s_cbranch_scc0 L_sp2
L_sp2_ret:
    s_mov_b32 s35, 1
    buffer_load_dword v128, v126, s[16:19], s70 offen offset:2560 sc1
    v_mfma_f32_16x16x32_bf16 v[28:31], a[132:135], v[80:83], v[28:31]
    buffer_load_dwordx4 a[60:63], v124, s[16:19], s69 offen sc1
    v_mfma_f32_16x16x32_bf16 v[32:35], a[136:139], v[80:83], v[32:35]
    v_mfma_f32_16x16x32_bf16 v[16:19], v[250:253], v[132:135], v[16:19]
    v_mfma_f32_16x16x32_bf16 v[20:23], v[248:251], v[132:135], v[20:23]
    v_mfma_f32_16x16x32_bf16 v[24:27], v[250:253], v[136:139], v[24:27]
    v_mfma_f32_16x16x32_bf16 v[28:31], v[248:251], v[136:139], v[28:31]
    v_mfma_f32_16x16x32_bf16 v[32:35], v[250:253], v[140:143], v[32:35]
    v_mfma_f32_16x16x32_bf16 v[16:19], v[250:253], v[142:145], v[16:19]
    v_mfma_f32_16x16x32_bf16 v[20:23], v[248:251], v[142:145], v[20:23]
    v_mfma_f32_16x16x32_bf16 v[24:27], v[250:253], v[146:149], v[24:27]
    v_mfma_f32_16x16x32_bf16 v[28:31], v[248:251], v[146:149], v[28:31]
    v_mfma_f32_16x16x32_bf16 v[32:35], v[250:253], v[150:153], v[32:35]
    buffer_load_dwordx4 a[64:67], v124, s[16:19], s69 offen offset:1024 sc1
    v_mfma_f32_16x16x32_bf16 v[16:19], a[140:143], v[84:87], v[16:19]
    buffer_load_dwordx2 a[68:69], v125, s[16:19], s69 offen offset:2048 sc1
    v_mfma_f32_16x16x32_bf16 v[20:23], a[144:147], v[84:87], v[20:23]
    s_mov_b32 s61, 0
    buffer_load_dwordx2 v[100:101], v121, s[16:19], s61 offen sc1
    v_mfma_f32_16x16x32_bf16 v[24:27], a[148:151], v[84:87], v[24:27]
    s_mov_b32 s61, 10240
    buffer_load_dwordx2 v[102:103], v120, s[16:19], s61 offen sc1
    v_mfma_f32_16x16x32_bf16 v[28:31], a[152:155], v[84:87], v[28:31]
    s_mov_b32 s61, 20480
    buffer_load_dwordx2 v[104:105], v120, s[16:19], s61 offen sc1
    v_mfma_f32_16x16x32_bf16 v[32:35], a[156:159], v[84:87], v[32:35]
    s_or_b32 s61, s75, 30720
    buffer_load_dwordx2 v[106:107], v120, s[16:19], s61 offen sc1
    s_waitcnt lgkmcnt(0)
    v_mfma_f32_16x16x32_bf16 v[16:19], a[160:163], v[56:59], v[16:19]
    s_waitcnt vmcnt(8)
    buffer_store_dword v123, v254, s[16:19], s78 offen offset:2560 sc1
    s_or_b32 s61, s75, 40960
    buffer_load_dwordx2 v[108:109], v120, s[16:19], s61 offen sc1
    v_cndmask_b32 v111, v8, v9, s[76:77]
    v_mov_b32 v8, 84151308
    v_mfma_f32_16x16x32_bf16 v[20:23], a[164:167], v[56:59], v[20:23]
    ds_read_b64_tr_b16 v[72:73], v14 offset:49152
    buffer_load_dwordx4 v[132:135], v122, s[16:19], 0 offen offset:0 sc1
    v_mov_b32 v9, 50465804
    v_mfma_f32_16x16x32_bf16 v[24:27], a[168:171], v[56:59], v[24:27]
    ds_read_b64_tr_b16 v[74:75], v14 offset:49664
    buffer_load_dwordx4 v[136:139], v122, s[16:19], 0 offen offset:64 sc1
    v_cndmask_b32 v112, v8, v9, s[76:77]
    v_mfma_f32_16x16x32_bf16 v[28:31], a[172:175], v[56:59], v[28:31]
    buffer_load_dwordx4 v[140:143], v122, s[16:19], 0 offen offset:128 sc1
    v_mov_b32 v8, 117836812
    v_mfma_f32_16x16x32_bf16 v[32:35], a[176:179], v[56:59], v[32:35]
    ds_read_b64_tr_b16 v[76:77], v14 offset:53248
    buffer_load_dwordx4 v[144:147], v122, s[16:19], s75 offen offset:192 sc1
    v_mov_b32 v9, 16780300
    v_mfma_f32_16x16x32_bf16 v[16:19], a[180:183], v[60:63], v[16:19]
    ds_read_b64_tr_b16 v[78:79], v14 offset:53760
    buffer_load_dwordx4 v[148:151], v122, s[16:19], s75 offen offset:256 sc1
    v_cndmask_b32 v113, v8, v9, s[76:77]
    v_mfma_f32_16x16x32_bf16 v[20:23], a[184:187], v[60:63], v[20:23]
    ds_read_b64_tr_b16 v[80:81], v14 offset:57344
    s_lshl_b32 s62, s3, 1
    v_mfma_f32_16x16x32_bf16 v[24:27], a[188:191], v[60:63], v[24:27]
    ds_read_b64_tr_b16 v[82:83], v14 offset:57856
    v_lshrrev_b32 v5, 1, v3
    v_mfma_f32_16x16x32_bf16 v[28:31], a[192:195], v[60:63], v[28:31]
    v_add_u32 v5, s62, v5
    v_mfma_f32_16x16x32_bf16 v[32:35], a[196:199], v[60:63], v[32:35]
    ds_read_b64_tr_b16 v[84:85], v14 offset:61440
    v_and_b32 v6, 7, v2
    v_mfma_f32_16x16x32_bf16 v[16:19], a[200:203], v[64:67], v[16:19]
    ds_read_b64_tr_b16 v[86:87], v14 offset:61952
    v_xor_b32 v5, v5, v6
    v_mfma_f32_16x16x32_bf16 v[20:23], a[204:207], v[64:67], v[20:23]
    v_lshlrev_b32 v5, 4, v5
    v_mfma_f32_16x16x32_bf16 v[24:27], a[208:211], v[64:67], v[24:27]
    v_lshl_add_u32 v5, v2, 7, v5
    v_mfma_f32_16x16x32_bf16 v[28:31], a[212:215], v[64:67], v[28:31]
    v_and_b32 v6, 1, v3
    v_mfma_f32_16x16x32_bf16 v[32:35], a[216:219], v[64:67], v[32:35]
    v_lshl_add_u32 v5, v6, 3, v5
    v_mfma_f32_16x16x32_bf16 v[16:19], a[220:223], v[68:71], v[16:19]
    v_add_u32 v114, 135168, v5
    v_mfma_f32_16x16x32_bf16 v[20:23], a[224:227], v[68:71], v[20:23]
    v_lshrrev_b32 v5, 3, v1
    v_mfma_f32_16x16x32_bf16 v[24:27], a[228:231], v[68:71], v[24:27]
    v_and_b32 v6, 7, v1
    v_mfma_f32_16x16x32_bf16 v[28:31], a[232:235], v[68:71], v[28:31]
    v_xor_b32 v7, v5, v6
    v_mfma_f32_16x16x32_bf16 v[32:35], a[236:239], v[68:71], v[32:35]
    v_lshlrev_b32 v7, 4, v7
    s_waitcnt lgkmcnt(0)
    v_mfma_f32_16x16x32_bf16 v[16:19], a[240:243], v[72:75], v[16:19]
    v_lshl_add_u32 v7, v5, 7, v7
    s_lshl_b32 s34, s3, 10
    s_add_u32 s34, s34, 135168
    v_add_u32 v115, s34, v7
    v_mfma_f32_16x16x32_bf16 v[20:23], a[244:247], v[72:75], v[20:23]
    s_lshl_b32 s34, s6, 7
    v_lshl_add_u32 v6, v6, 4, s34
    v_and_b32 v5, 3, v5
    v_mfma_f32_16x16x32_bf16 v[24:27], a[248:251], v[72:75], v[24:27]
    v_mfma_f32_16x16x32_bf16 v[28:31], a[252:255], v[72:75], v[28:31]
    s_waitcnt vmcnt(14)
    v_cmp_eq_u32 s[80:81], s7, v128
    s_and_b32 s97, s80, s35
    s_cmp_eq_u32 s97, s35
    s_cbranch_scc0 L_sp3
L_sp3_ret:
    buffer_load_dwordx4 a[72:75], v124, s[16:19], s70 offen sc1
    buffer_load_dwordx4 a[76:79], v124, s[16:19], s70 offen offset:1024 sc1
    buffer_load_dwordx2 a[80:81], v125, s[16:19], s70 offen offset:2048 sc1
    v_mfma_f32_16x16x32_bf16 v[32:35], v[152:155], v[72:75], v[32:35]
    v_lshrrev_b32 v7, 5, v1
    s_add_u32 s62, s62, s94
    v_add_u32 v7, s62, v7
    v_mfma_f32_16x16x32_bf16 v[16:19], v[156:159], v[76:79], v[16:19]
    s_add_u32 s94, s94, 20
    s_min_u32 s94, s94, 512
    s_movk_i32 s96, 1152
    v_mfma_f32_16x16x32_bf16 v[20:23], v[160:163], v[76:79], v[20:23]
    v_cmp_eq_u32 vcc, 0, v7
    v_mov_b32 v8, 512
    v_add_u32 v9, 1, v5
    v_mfma_f32_16x16x32_bf16 v[24:27], v[164:167], v[76:79], v[24:27]
    v_cndmask_b32 v8, v7, v8, vcc
    v_cmp_lt_u32 vcc, 1, v5
    v_sub_u32 v8, 0, v8
    v_mfma_f32_16x16x32_bf16 v[28:31], v[168:171], v[76:79], v[28:31]
    v_lshrrev_b32 v9, 1, v9
    v_cndmask_b32 v8, v7, v8, vcc
    v_lshl_add_u32 v116, v9, 10, v8
    v_mfma_f32_16x16x32_bf16 v[32:35], v[172:175], v[76:79], v[32:35]
    v_cmp_gt_u32 vcc, s94, v7
    v_mad_u32_u24 v116, v116, s96, v6
    v_mov_b32 v8, 1073741824
    v_mfma_f32_16x16x32_bf16 v[16:19], v[176:179], v[80:83], v[16:19]
    v_cndmask_b32 v116, v8, v116, vcc
    v_add_u32 v7, 8, v7
    v_cmp_eq_u32 vcc, 0, v7
    v_mfma_f32_16x16x32_bf16 v[20:23], v[180:183], v[80:83], v[20:23]
    v_mov_b32 v8, 512
    v_add_u32 v9, 1, v5
    v_cndmask_b32 v8, v7, v8, vcc
    v_mfma_f32_16x16x32_bf16 v[24:27], v[184:187], v[80:83], v[24:27]
    v_cmp_lt_u32 vcc, 1, v5
    v_sub_u32 v8, 0, v8
    v_lshrrev_b32 v9, 1, v9
    v_mfma_f32_16x16x32_bf16 v[28:31], v[188:191], v[80:83], v[28:31]
    v_cndmask_b32 v8, v7, v8, vcc
    v_lshl_add_u32 v117, v9, 10, v8
    v_cmp_gt_u32 vcc, s94, v7
    v_mfma_f32_16x16x32_bf16 v[32:35], v[192:195], v[80:83], v[32:35]
    v_mad_u32_u24 v117, v117, s96, v6
    v_mov_b32 v8, 1073741824
    v_cndmask_b32 v117, v8, v117, vcc
    v_mfma_f32_16x16x32_bf16 v[36:39], v[196:199], v[84:87], v[16:19]
    v_add_u32 v7, 8, v7
    v_cmp_eq_u32 vcc, 0, v7
    v_mov_b32 v8, 512
    v_mfma_f32_16x16x32_bf16 v[40:43], v[200:203], v[84:87], v[20:23]
    v_add_u32 v9, 1, v5
    v_cndmask_b32 v8, v7, v8, vcc
    v_cmp_lt_u32 vcc, 1, v5
    v_mfma_f32_16x16x32_bf16 v[44:47], v[204:207], v[84:87], v[24:27]
    v_sub_u32 v8, 0, v8
    v_lshrrev_b32 v9, 1, v9
    v_cndmask_b32 v8, v7, v8, vcc
    v_mfma_f32_16x16x32_bf16 v[48:51], v[208:211], v[84:87], v[28:31]
    v_lshl_add_u32 v118, v9, 10, v8
    v_cmp_gt_u32 vcc, s94, v7
    v_mad_u32_u24 v118, v118, s96, v6
    v_mfma_f32_16x16x32_bf16 v[52:55], v[212:215], v[84:87], v[32:35]
    v_mov_b32 v8, 1073741824
    v_cndmask_b32 v118, v8, v118, vcc
    v_add_u32 v7, 8, v7
    buffer_load_dword v128, v126, s[16:19], s71 offen offset:2560 sc1
    v_mfma_f32_16x16x32_bf16 v[36:39], v[250:253], v[216:219], v[36:39]
    v_mfma_f32_16x16x32_bf16 v[40:43], v[248:251], v[216:219], v[40:43]
    v_mfma_f32_16x16x32_bf16 v[44:47], v[250:253], v[220:223], v[44:47]
    v_mfma_f32_16x16x32_bf16 v[48:51], v[248:251], v[220:223], v[48:51]
    v_mfma_f32_16x16x32_bf16 v[52:55], v[250:253], v[224:227], v[52:55]
    v_mfma_f32_16x16x32_bf16 v[36:39], v[250:253], v[226:229], v[36:39]
    v_mfma_f32_16x16x32_bf16 v[40:43], v[248:251], v[226:229], v[40:43]
    v_mfma_f32_16x16x32_bf16 v[44:47], v[250:253], v[230:233], v[44:47]
    v_mfma_f32_16x16x32_bf16 v[48:51], v[248:251], v[230:233], v[48:51]
    v_mfma_f32_16x16x32_bf16 v[52:55], v[250:253], v[234:237], v[52:55]
    v_mfma_f32_16x16x32_bf16 v[36:39], v[250:253], v[236:239], v[36:39]
    v_mfma_f32_16x16x32_bf16 v[40:43], v[248:251], v[236:239], v[40:43]
    v_mfma_f32_16x16x32_bf16 v[44:47], v[250:253], v[240:243], v[44:47]
    v_mfma_f32_16x16x32_bf16 v[48:51], v[248:251], v[240:243], v[48:51]
    v_mfma_f32_16x16x32_bf16 v[52:55], v[250:253], v[244:247], v[52:55]
    s_waitcnt vmcnt(15)
    v_mfma_f32_16x16x32_bf16 v[36:39], v[250:253], a[60:63], v[36:39]
    v_mfma_f32_16x16x32_bf16 v[40:43], v[248:251], a[60:63], v[40:43]
    v_mfma_f32_16x16x32_bf16 v[44:47], v[250:253], a[64:67], v[44:47]
    v_mfma_f32_16x16x32_bf16 v[48:51], v[248:251], a[64:67], v[48:51]
    v_mfma_f32_16x16x32_bf16 v[52:55], v[250:253], a[68:71], v[52:55]
    s_waitcnt vmcnt(4)
    v_perm_b32 v56, v101, v100, v110
    v_perm_b32 v57, v101, v100, v111
    v_perm_b32 v58, v101, v100, v112
    v_perm_b32 v59, v101, v100, v113
    v_perm_b32 v60, v103, v102, v110
    v_perm_b32 v61, v103, v102, v111
    v_perm_b32 v62, v103, v102, v112
    v_perm_b32 v63, v103, v102, v113
    v_perm_b32 v64, v105, v104, v110
    v_perm_b32 v65, v105, v104, v111
    v_perm_b32 v66, v105, v104, v112
    v_perm_b32 v67, v105, v104, v113
    v_perm_b32 v68, v107, v106, v110
    v_perm_b32 v69, v107, v106, v111
    v_perm_b32 v70, v107, v106, v112
    v_perm_b32 v71, v107, v106, v113
    v_perm_b32 v72, v109, v108, v110
    v_perm_b32 v73, v109, v108, v111
    v_perm_b32 v74, v109, v108, v112
    v_perm_b32 v75, v109, v108, v113
    s_waitcnt vmcnt(0)
    v_cmp_eq_u32 vcc, s7, v128
    s_and_b32 s97, vcc_lo, s35
    s_cmp_eq_u32 s97, s35
    s_cbranch_scc0 L_sp4
L_sp4_ret:
    buffer_load_dwordx4 a[84:87], v124, s[16:19], s71 offen sc1
    buffer_load_dwordx4 a[88:91], v124, s[16:19], s71 offen offset:1024 sc1
    buffer_load_dwordx2 a[92:93], v125, s[16:19], s71 offen offset:2048 sc1
    v_mul_f32 v56, v56, v132
    v_mul_f32 v57, v57, v133
    v_mul_f32 v58, v58, v134
    v_mul_f32 v59, v59, v135
    v_mul_f32 v60, v60, v136
    v_mul_f32 v61, v61, v137
    v_mul_f32 v62, v62, v138
    v_mul_f32 v63, v63, v139
    v_mul_f32 v64, v64, v140
    v_mul_f32 v65, v65, v141
    v_mul_f32 v66, v66, v142
    v_mul_f32 v67, v67, v143
    v_mul_f32 v68, v68, v144
    v_mul_f32 v69, v69, v145
    v_mul_f32 v70, v70, v146
    v_mul_f32 v71, v71, v147
    v_mul_f32 v72, v72, v148
    v_mul_f32 v73, v73, v149
    v_mul_f32 v74, v74, v150
    v_mul_f32 v75, v75, v151
    v_sub_f32 v132, 1.0, v132
    v_sub_f32 v133, 1.0, v133
    v_sub_f32 v134, 1.0, v134
    v_sub_f32 v135, 1.0, v135
    v_sub_f32 v136, 1.0, v136
    v_sub_f32 v137, 1.0, v137
    v_sub_f32 v138, 1.0, v138
    v_sub_f32 v139, 1.0, v139
    v_sub_f32 v140, 1.0, v140
    v_sub_f32 v141, 1.0, v141
    v_sub_f32 v142, 1.0, v142
    v_sub_f32 v143, 1.0, v143
    v_sub_f32 v144, 1.0, v144
    v_sub_f32 v145, 1.0, v145
    v_sub_f32 v146, 1.0, v146
    v_sub_f32 v147, 1.0, v147
    v_sub_f32 v148, 1.0, v148
    v_sub_f32 v149, 1.0, v149
    v_sub_f32 v150, 1.0, v150
    v_sub_f32 v151, 1.0, v151
    s_waitcnt vmcnt(4)
    v_mfma_f32_16x16x32_bf16 v[36:39], v[250:253], a[72:75], v[36:39]
    v_mfma_f32_16x16x32_bf16 v[40:43], v[248:251], a[72:75], v[40:43]
    v_mfma_f32_16x16x32_bf16 v[44:47], v[250:253], a[76:79], v[44:47]
    v_mfma_f32_16x16x32_bf16 v[48:51], v[248:251], a[76:79], v[48:51]
    v_mfma_f32_16x16x32_bf16 v[52:55], v[250:253], a[80:83], v[52:55]
    s_waitcnt vmcnt(0)
    v_mfma_f32_16x16x32_bf16 v[36:39], v[250:253], a[84:87], v[36:39]
    v_mfma_f32_16x16x32_bf16 v[40:43], v[248:251], a[84:87], v[40:43]
    v_mfma_f32_16x16x32_bf16 v[44:47], v[250:253], a[88:91], v[44:47]
    v_mfma_f32_16x16x32_bf16 v[48:51], v[248:251], a[88:91], v[48:51]
    v_mfma_f32_16x16x32_bf16 v[52:55], v[250:253], a[92:95], v[52:55]
    s_nop 3
    v_fmac_f32 v56, v36, v132
    v_fmac_f32 v57, v37, v133
    v_fmac_f32 v58, v38, v134
    v_fmac_f32 v59, v39, v135
    v_cvt_pk_bf16_f32 v88, v56, v57
    v_cvt_pk_bf16_f32 v89, v58, v59
    v_fmac_f32 v60, v40, v136
    v_fmac_f32 v61, v41, v137
    v_fmac_f32 v62, v42, v138
    v_fmac_f32 v63, v43, v139
    v_cvt_pk_bf16_f32 v90, v60, v61
    v_cvt_pk_bf16_f32 v91, v62, v63
    v_fmac_f32 v64, v44, v140
    v_fmac_f32 v65, v45, v141
    v_fmac_f32 v66, v46, v142
    v_fmac_f32 v67, v47, v143
    v_cvt_pk_bf16_f32 v92, v64, v65
    v_cvt_pk_bf16_f32 v93, v66, v67
    v_fmac_f32 v68, v48, v144
    v_fmac_f32 v69, v49, v145
    v_fmac_f32 v70, v50, v146
    v_fmac_f32 v71, v51, v147
    v_cvt_pk_bf16_f32 v94, v68, v69
    v_cvt_pk_bf16_f32 v95, v70, v71
    v_fmac_f32 v72, v52, v148
    v_fmac_f32 v73, v53, v149
    v_fmac_f32 v74, v54, v150
    v_fmac_f32 v75, v55, v151
    v_cvt_pk_bf16_f32 v96, v72, v73
    v_cvt_pk_bf16_f32 v97, v74, v75
    v_mov_b32 v98, 0
    v_mov_b32 v99, 0
    v_mfma_f32_16x16x32_bf16 v[16:19], v[88:91], v[250:253], 0
    v_mfma_f32_16x16x32_bf16 v[20:23], v[88:91], v[248:251], 0
    v_mfma_f32_16x16x32_bf16 v[24:27], v[92:95], v[250:253], 0
    v_mfma_f32_16x16x32_bf16 v[28:31], v[92:95], v[248:251], 0
    v_mfma_f32_16x16x32_bf16 v[32:35], v[96:99], v[250:253], 0
    s_nop 3
    v_cvt_pk_bf16_f32 v56, v16, v17
    v_cvt_pk_bf16_f32 v57, v18, v19
    ds_write_b64 v114, v[56:57] offset:0
    v_cvt_pk_bf16_f32 v58, v20, v21
    v_cvt_pk_bf16_f32 v59, v22, v23
    ds_write_b64 v114, v[58:59] offset:2048
    v_cvt_pk_bf16_f32 v60, v24, v25
    v_cvt_pk_bf16_f32 v61, v26, v27
    ds_write_b64 v114, v[60:61] offset:4096
    v_cvt_pk_bf16_f32 v62, v28, v29
    v_cvt_pk_bf16_f32 v63, v30, v31
    ds_write_b64 v114, v[62:63] offset:6144
    v_cvt_pk_bf16_f32 v64, v32, v33
    v_cvt_pk_bf16_f32 v65, v34, v35
    ds_write_b64 v114, v[64:65] offset:8192
    s_waitcnt lgkmcnt(0)
    s_barrier
    ds_read_b128 v[68:71], v115 offset:0
    ds_read_b128 v[72:75], v115 offset:4096
    ds_read_b128 v[76:79], v115 offset:8192
    s_waitcnt lgkmcnt(2)
    buffer_store_dwordx4 v[68:71], v116, s[24:27], 0 offen sc1
    s_waitcnt lgkmcnt(1)
    buffer_store_dwordx4 v[72:75], v117, s[24:27], 0 offen sc1
    s_waitcnt lgkmcnt(0)
    buffer_store_dwordx4 v[76:79], v118, s[24:27], 0 offen sc1
    s_or_b32 s68, s2, s3
    s_cmp_eq_u32 s68, 0
    s_cbranch_scc0 L_noepoch
    buffer_store_dword v123, v126, s[16:19], 0 offen sc1
L_noepoch:
    s_endpgm
L_once1:
    buffer_store_dword v123, v122, s[16:19], 0 offen sc1
    s_branch L_once1_ret
L_ep0:
    buffer_load_dword v128, v129, s[16:19], 0 offen sc1
    s_branch L_ep0_ret
L_ep1:
    v_cmp_eq_u32 vcc, s7, v128
    s_and_b32 s97, vcc_lo, s35
    s_cmp_eq_u32 s97, s35
    s_cbranch_scc0 L_sp1
L_sp1_ret:
    s_cmp_eq_u32 s63, 1
    s_cbranch_scc1 L_ep2
    buffer_load_dwordx4 v[216:219], v124, s[16:19], s94 offen sc1
    buffer_load_dwordx4 v[220:223], v124, s[16:19], s94 offen offset:1024 sc1
    buffer_load_dwordx2 v[224:225], v125, s[16:19], s94 offen offset:2048 sc1
    buffer_load_dwordx4 v[226:229], v124, s[16:19], s96 offen sc1
    buffer_load_dwordx4 v[230:233], v124, s[16:19], s96 offen offset:1024 sc1
    buffer_load_dwordx2 v[234:235], v125, s[16:19], s96 offen offset:2048 sc1
    buffer_load_dwordx4 v[236:239], v124, s[16:19], s34 offen sc1
    buffer_load_dwordx4 v[240:243], v124, s[16:19], s34 offen offset:1024 sc1
    buffer_load_dwordx2 v[244:245], v125, s[16:19], s34 offen offset:2048 sc1
    s_movk_i32 s35, 0x18
    s_branch L_ep1_ret
L_ep2:
    buffer_load_dwordx4 v[132:135], v124, s[16:19], s100 offen sc1
    buffer_load_dwordx4 v[136:139], v124, s[16:19], s100 offen offset:1024 sc1
    buffer_load_dwordx2 v[140:141], v125, s[16:19], s100 offen offset:2048 sc1
    buffer_load_dwordx4 v[142:145], v124, s[16:19], s101 offen sc1
    buffer_load_dwordx4 v[146:149], v124, s[16:19], s101 offen offset:1024 sc1
    buffer_load_dwordx2 v[150:151], v125, s[16:19], s101 offen offset:2048 sc1
    s_branch L_ep1_ret
L_sp1:
    s_mov_b32 s98, 1048576
L_sp1_l:
    buffer_load_dword v128, v129, s[16:19], 0 offen sc1
    s_sub_u32 s98, s98, 1
    s_cmp_eq_u32 s98, 0
    s_cbranch_scc1 L_sp1_ret
    s_waitcnt vmcnt(0)
    v_cmp_eq_u32 vcc, s7, v128
    s_and_b32 s97, vcc_lo, s35
    s_cmp_eq_u32 s97, s35
    s_cbranch_scc1 L_sp1_ret
    s_sleep 2
    s_branch L_sp1_l
L_sp2:
    s_mov_b32 s98, 1048576
L_sp2_l:
    buffer_load_dword v128, v127, s[16:19], 0 offen sc1
    s_sub_u32 s98, s98, 1
    s_cmp_eq_u32 s98, 0
    s_cbranch_scc1 L_sp2_ret
    s_waitcnt vmcnt(0)
    v_cmp_eq_u32 vcc, s7, v128
    s_and_b32 s97, vcc_lo, s35
    s_cmp_eq_u32 s97, s35
    s_cbranch_scc1 L_sp2_ret
    s_sleep 2
    s_branch L_sp2_l
L_sp3:
    s_mov_b32 s98, 1048576
L_sp3_l:
    buffer_load_dword v128, v126, s[16:19], s70 offen offset:2560 sc1
    s_sub_u32 s98, s98, 1
    s_cmp_eq_u32 s98, 0
    s_cbranch_scc1 L_sp3_ret
    s_waitcnt vmcnt(0)
    v_cmp_eq_u32 s[80:81], s7, v128
    s_and_b32 s97, s80, s35
    s_cmp_eq_u32 s97, s35
    s_cbranch_scc1 L_sp3_ret
    s_sleep 2
    s_branch L_sp3_l
L_sp4:
    s_mov_b32 s98, 1048576
L_sp4_l:
    buffer_load_dword v128, v126, s[16:19], s71 offen offset:2560 sc1
    s_sub_u32 s98, s98, 1
    s_cmp_eq_u32 s98, 0
    s_cbranch_scc1 L_sp4_ret
    s_waitcnt vmcnt(0)
    v_cmp_eq_u32 vcc, s7, v128
    s_and_b32 s97, vcc_lo, s35
    s_cmp_eq_u32 s97, s35
    s_cbranch_scc1 L_sp4_ret
    s_sleep 2
    s_branch L_sp4_l
L_spare:
    s_getpc_b64 s[68:69]
L_pca:
    s_sub_u32 s68, s68, L_pca-gated_mix__spectral_fnet__dense_activation_relu__prompt_kernel
    s_subb_u32 s69, s69, 0
    v_lshlrev_b32 v4, 7, v0
    v_min_u32 v4, L_end-gated_mix__spectral_fnet__dense_activation_relu__prompt_kernel, v4
    v_mov_b32 v5, s69
    v_add_co_u32 v4, vcc, s68, v4
    s_nop 1
    v_addc_co_u32 v5, vcc, 0, v5, vcc
    global_load_dword v254, v[4:5], off
    s_sub_u32 s62, s62, s63
    s_and_b32 s65, s2, 7
    s_mul_i32 s64, s65, 3
    s_add_u32 s64, s64, s62
    s_lshl_b32 s62, s62, 1
    s_add_u32 s62, s62, s65
    s_add_u32 s62, s62, 12
    s_cmp_ge_u32 s65, 6
    s_cselect_b32 s64, s62, s64
    s_waitcnt lgkmcnt(0)
    s_mov_b32 s8, s50
    s_mov_b32 s9, s51
    s_mov_b32 s10, 5308416
    s_mov_b32 s11, 0x20000
    s_mov_b32 s12, s48
    s_mov_b32 s13, s49
    s_mov_b32 s14, 5308416
    s_mov_b32 s15, 0x20000
    s_lshl_b32 s65, s64, 8
    v_add_u32 v4, s65, v0
    v_lshlrev_b32 v255, 7, v4
    v_lshrrev_b32 v252, 9, v4
    v_lshlrev_b32 v252, 7, v252
    v_lshlrev_b32 v253, 10, v4
    s_mov_b32 s75, 0
    s_mov_b32 s76, 0
    buffer_load_dword v254, v253, s[12:15], s76 offen
    s_add_u32 s76, s76, 128
    buffer_load_dword v254, v253, s[12:15], s76 offen
    s_add_u32 s76, s76, 128
    s_cmp_ge_u32 s64, 20
    s_cbranch_scc1 L_idle
    s_cmp_ge_u32 s64, 10
    s_cselect_b32 s4, 1, 0
    s_cselect_b32 s65, 10, 0
    s_sub_u32 s65, s64, s65
    s_cmp_ge_u32 s65, 5
    s_cselect_b32 s5, 1, 0
    s_cselect_b32 s66, 5, 0
    s_sub_u32 s6, s65, s66
    s_waitcnt lgkmcnt(0)
    s_load_dword s7, s[58:59], 0
    s_mov_b32 s16, s58
    s_mov_b32 s17, s59
    s_mov_b32 s18, 50331648
    s_mov_b32 s19, 0x20000
    s_mov_b32 s20, s36
    s_mov_b32 s21, s37
    s_mov_b32 s22, 2359296
    s_mov_b32 s23, 0x20000
    s_mov_b32 s24, s52
    s_mov_b32 s25, s53
    s_mov_b32 s26, 1152
    s_mov_b32 s27, 0x20000
    s_lshl_b32 s66, s5, 7
    s_lshl_b32 s67, s3, 5
    s_add_u32 s66, s66, s67
    s_lshl_b32 s66, s66, 1
    s_add_u32 s66, s66, s4
    v_lshl_add_u32 v4, v2, 1, s66
    v_cmp_eq_u32 vcc, 0, v4
    v_mov_b32 v5, 512
    v_add_u32 v6, 32, v4
    v_cndmask_b32 v5, v4, v5, vcc
    v_cvt_f32_u32 v10, v4
    v_cvt_f32_u32 v11, v6
    v_cvt_f32_u32 v12, v5
    v_lshlrev_b32 v7, 4, v3
    v_cvt_f32_u32 v7, v7
    v_mul_f32 v10, 0xba000000, v10
    v_mul_f32 v11, 0xba000000, v11
    v_mul_f32 v12, 0xba000000, v12
    s_mul_i32 s70, s4, 0xffff
    v_mov_b32 v8, s70
    v_cmp_eq_u32 vcc, 0, v3
    v_and_b32 v9, 1, v2
    v_lshlrev_b32 v9, 15, v9
    v_cndmask_b32 v8, 0, v8, vcc
    v_xor_b32 v9, 0xbf80, v9
    v_mul_f32 v16, v7, v11
    v_mul_f32 v17, 0x42400000, v11
    s_mov_b32 s63, 0
L_trig:
    s_cmp_eq_u32 s63, 0
    s_cselect_b64 vcc, -1, 0
    v_cndmask_b32 v19, v12, v11, vcc
    v_mul_f32 v18, v7, v19
    v_mul_f32 v20, 0x42400000, v19
    v_cos_f32 v24, v16
    v_sin_f32 v28, v18
    v_add_f32 v16, v16, v11
    v_add_f32 v18, v18, v19
    v_cos_f32 v25, v16
    v_sin_f32 v29, v18
    v_add_f32 v16, v16, v11
    v_add_f32 v18, v18, v19
    v_cos_f32 v26, v16
    v_sin_f32 v30, v18
    v_add_f32 v16, v16, v11
    v_add_f32 v18, v18, v19
    v_cos_f32 v27, v16
    v_sin_f32 v31, v18
    v_add_f32 v16, v16, v11
    v_add_f32 v18, v18, v19
    v_cvt_pk_bf16_f32 v120, v24, v26
    v_cvt_pk_bf16_f32 v124, v25, v27
    v_cvt_pk_bf16_f32 v184, v28, v30
    v_cvt_pk_bf16_f32 v188, v29, v31
    v_cos_f32 v24, v16
    v_sin_f32 v28, v18
    v_add_f32 v16, v16, v11
    v_add_f32 v18, v18, v19
    v_cos_f32 v25, v16
    v_sin_f32 v29, v18
    v_add_f32 v16, v16, v11
    v_add_f32 v18, v18, v19
    v_cos_f32 v26, v16
    v_sin_f32 v30, v18
    v_add_f32 v16, v16, v11
    v_add_f32 v18, v18, v19
    v_cos_f32 v27, v16
    v_sin_f32 v31, v18
    v_add_f32 v16, v16, v11
    v_add_f32 v18, v18, v19
    v_cvt_pk_bf16_f32 v121, v24, v26
    v_cvt_pk_bf16_f32 v125, v25, v27
    v_cvt_pk_bf16_f32 v185, v28, v30
    v_cvt_pk_bf16_f32 v189, v29, v31
    v_cos_f32 v24, v16
    v_sin_f32 v28, v18
    v_add_f32 v16, v16, v11
    v_add_f32 v18, v18, v19
    v_cos_f32 v25, v16
    v_sin_f32 v29, v18
    v_add_f32 v16, v16, v11
    v_add_f32 v18, v18, v19
    v_cos_f32 v26, v16
    v_sin_f32 v30, v18
    v_add_f32 v16, v16, v11
    v_add_f32 v18, v18, v19
    v_cos_f32 v27, v16
    v_sin_f32 v31, v18
    v_add_f32 v16, v16, v11
    v_add_f32 v18, v18, v19
    v_cvt_pk_bf16_f32 v122, v24, v26
    v_cvt_pk_bf16_f32 v126, v25, v27
    v_cvt_pk_bf16_f32 v186, v28, v30
    v_cvt_pk_bf16_f32 v190, v29, v31
    v_cos_f32 v24, v16
    v_sin_f32 v28, v18
    v_add_f32 v16, v16, v11
    v_add_f32 v18, v18, v19
    v_cos_f32 v25, v16
    v_sin_f32 v29, v18
    v_add_f32 v16, v16, v11
    v_add_f32 v18, v18, v19
    v_cos_f32 v26, v16
    v_sin_f32 v30, v18
    v_add_f32 v16, v16, v11
    v_add_f32 v18, v18, v19
    v_cos_f32 v27, v16
    v_sin_f32 v31, v18
    v_add_f32 v16, v16, v11
    v_add_f32 v18, v18, v19
    v_cvt_pk_bf16_f32 v123, v24, v26
    v_cvt_pk_bf16_f32 v127, v25, v27
    v_cvt_pk_bf16_f32 v187, v28, v30
    v_cvt_pk_bf16_f32 v191, v29, v31
    v_add_f32 v16, v16, v17
    v_add_f32 v18, v18, v20
    v_cos_f32 v24, v16
    v_sin_f32 v28, v18
    v_add_f32 v16, v16, v11
    v_add_f32 v18, v18, v19
    v_cos_f32 v25, v16
    v_sin_f32 v29, v18
    v_add_f32 v16, v16, v11
    v_add_f32 v18, v18, v19
    v_cos_f32 v26, v16
    v_sin_f32 v30, v18
    v_add_f32 v16, v16, v11
    v_add_f32 v18, v18, v19
    v_cos_f32 v27, v16
    v_sin_f32 v31, v18
    v_add_f32 v16, v16, v11
    v_add_f32 v18, v18, v19
    v_cvt_pk_bf16_f32 v128, v24, v26
    v_cvt_pk_bf16_f32 v132, v25, v27
    v_cvt_pk_bf16_f32 v192, v28, v30
    v_cvt_pk_bf16_f32 v196, v29, v31
    v_cos_f32 v24, v16
    v_sin_f32 v28, v18
    v_add_f32 v16, v16, v11
    v_add_f32 v18, v18, v19
    v_cos_f32 v25, v16
    v_sin_f32 v29, v18
    v_add_f32 v16, v16, v11
    v_add_f32 v18, v18, v19
    v_cos_f32 v26, v16
    v_sin_f32 v30, v18
    v_add_f32 v16, v16, v11
    v_add_f32 v18, v18, v19
    v_cos_f32 v27, v16
    v_sin_f32 v31, v18
    v_add_f32 v16, v16, v11
    v_add_f32 v18, v18, v19
    v_cvt_pk_bf16_f32 v129, v24, v26
    v_cvt_pk_bf16_f32 v133, v25, v27
    v_cvt_pk_bf16_f32 v193, v28, v30
    v_cvt_pk_bf16_f32 v197, v29, v31
    v_cos_f32 v24, v16
    v_sin_f32 v28, v18
    v_add_f32 v16, v16, v11
    v_add_f32 v18, v18, v19
    v_cos_f32 v25, v16
    v_sin_f32 v29, v18
    v_add_f32 v16, v16, v11
    v_add_f32 v18, v18, v19
    v_cos_f32 v26, v16
    v_sin_f32 v30, v18
    v_add_f32 v16, v16, v11
    v_add_f32 v18, v18, v19
    v_cos_f32 v27, v16
    v_sin_f32 v31, v18
    v_add_f32 v16, v16, v11
    v_add_f32 v18, v18, v19
    v_cvt_pk_bf16_f32 v130, v24, v26
    v_cvt_pk_bf16_f32 v134, v25, v27
    v_cvt_pk_bf16_f32 v194, v28, v30
    v_cvt_pk_bf16_f32 v198, v29, v31
    v_cos_f32 v24, v16
    v_sin_f32 v28, v18
    v_add_f32 v16, v16, v11
    v_add_f32 v18, v18, v19
    v_cos_f32 v25, v16
    v_sin_f32 v29, v18
    v_add_f32 v16, v16, v11
    v_add_f32 v18, v18, v19
    v_cos_f32 v26, v16
    v_sin_f32 v30, v18
    v_add_f32 v16, v16, v11
    v_add_f32 v18, v18, v19
    v_cos_f32 v27, v16
    v_sin_f32 v31, v18
    v_add_f32 v16, v16, v11
    v_add_f32 v18, v18, v19
    v_cvt_pk_bf16_f32 v131, v24, v26
    v_cvt_pk_bf16_f32 v135, v25, v27
    v_cvt_pk_bf16_f32 v195, v28, v30
    v_cvt_pk_bf16_f32 v199, v29, v31
    v_add_f32 v16, v16, v17
    v_add_f32 v18, v18, v20
    buffer_load_dword v254, v253, s[12:15], s76 offen
    s_add_u32 s76, s76, 128
    v_cos_f32 v24, v16
    v_sin_f32 v28, v18
    v_add_f32 v16, v16, v11
    v_add_f32 v18, v18, v19
    v_cos_f32 v25, v16
    v_sin_f32 v29, v18
    v_add_f32 v16, v16, v11
    v_add_f32 v18, v18, v19
    v_cos_f32 v26, v16
    v_sin_f32 v30, v18
    v_add_f32 v16, v16, v11
    v_add_f32 v18, v18, v19
    v_cos_f32 v27, v16
    v_sin_f32 v31, v18
    v_add_f32 v16, v16, v11
    v_add_f32 v18, v18, v19
    v_cvt_pk_bf16_f32 v136, v24, v26
    v_cvt_pk_bf16_f32 v140, v25, v27
    v_cvt_pk_bf16_f32 v200, v28, v30
    v_cvt_pk_bf16_f32 v204, v29, v31
    v_cos_f32 v24, v16
    v_sin_f32 v28, v18
    v_add_f32 v16, v16, v11
    v_add_f32 v18, v18, v19
    v_cos_f32 v25, v16
    v_sin_f32 v29, v18
    v_add_f32 v16, v16, v11
    v_add_f32 v18, v18, v19
    v_cos_f32 v26, v16
    v_sin_f32 v30, v18
    v_add_f32 v16, v16, v11
    v_add_f32 v18, v18, v19
    v_cos_f32 v27, v16
    v_sin_f32 v31, v18
    v_add_f32 v16, v16, v11
    v_add_f32 v18, v18, v19
    v_cvt_pk_bf16_f32 v137, v24, v26
    v_cvt_pk_bf16_f32 v141, v25, v27
    v_cvt_pk_bf16_f32 v201, v28, v30
    v_cvt_pk_bf16_f32 v205, v29, v31
    v_cos_f32 v24, v16
    v_sin_f32 v28, v18
    v_add_f32 v16, v16, v11
    v_add_f32 v18, v18, v19
    v_cos_f32 v25, v16
    v_sin_f32 v29, v18
    v_add_f32 v16, v16, v11
    v_add_f32 v18, v18, v19
    v_cos_f32 v26, v16
    v_sin_f32 v30, v18
    v_add_f32 v16, v16, v11
    v_add_f32 v18, v18, v19
    v_cos_f32 v27, v16
    v_sin_f32 v31, v18
    v_add_f32 v16, v16, v11
    v_add_f32 v18, v18, v19
    v_cvt_pk_bf16_f32 v138, v24, v26
    v_cvt_pk_bf16_f32 v142, v25, v27
    v_cvt_pk_bf16_f32 v202, v28, v30
    v_cvt_pk_bf16_f32 v206, v29, v31
    v_cos_f32 v24, v16
    v_sin_f32 v28, v18
    v_add_f32 v16, v16, v11
    v_add_f32 v18, v18, v19
    v_cos_f32 v25, v16
    v_sin_f32 v29, v18
    v_add_f32 v16, v16, v11
    v_add_f32 v18, v18, v19
    v_cos_f32 v26, v16
    v_sin_f32 v30, v18
    v_add_f32 v16, v16, v11
    v_add_f32 v18, v18, v19
    v_cos_f32 v27, v16
    v_sin_f32 v31, v18
    v_add_f32 v16, v16, v11
    v_add_f32 v18, v18, v19
    v_cvt_pk_bf16_f32 v139, v24, v26
    v_cvt_pk_bf16_f32 v143, v25, v27
    v_cvt_pk_bf16_f32 v203, v28, v30
    v_cvt_pk_bf16_f32 v207, v29, v31
    v_add_f32 v16, v16, v17
    v_add_f32 v18, v18, v20
    v_cos_f32 v24, v16
    v_sin_f32 v28, v18
    v_add_f32 v16, v16, v11
    v_add_f32 v18, v18, v19
    v_cos_f32 v25, v16
    v_sin_f32 v29, v18
    v_add_f32 v16, v16, v11
    v_add_f32 v18, v18, v19
    v_cos_f32 v26, v16
    v_sin_f32 v30, v18
    v_add_f32 v16, v16, v11
    v_add_f32 v18, v18, v19
    v_cos_f32 v27, v16
    v_sin_f32 v31, v18
    v_add_f32 v16, v16, v11
    v_add_f32 v18, v18, v19
    v_cvt_pk_bf16_f32 v144, v24, v26
    v_cvt_pk_bf16_f32 v148, v25, v27
    v_cvt_pk_bf16_f32 v208, v28, v30
    v_cvt_pk_bf16_f32 v212, v29, v31
    v_cos_f32 v24, v16
    v_sin_f32 v28, v18
    v_add_f32 v16, v16, v11
    v_add_f32 v18, v18, v19
    v_cos_f32 v25, v16
    v_sin_f32 v29, v18
    v_add_f32 v16, v16, v11
    v_add_f32 v18, v18, v19
    v_cos_f32 v26, v16
    v_sin_f32 v30, v18
    v_add_f32 v16, v16, v11
    v_add_f32 v18, v18, v19
    v_cos_f32 v27, v16
    v_sin_f32 v31, v18
    v_add_f32 v16, v16, v11
    v_add_f32 v18, v18, v19
    v_cvt_pk_bf16_f32 v145, v24, v26
    v_cvt_pk_bf16_f32 v149, v25, v27
    v_cvt_pk_bf16_f32 v209, v28, v30
    v_cvt_pk_bf16_f32 v213, v29, v31
    v_cos_f32 v24, v16
    v_sin_f32 v28, v18
    v_add_f32 v16, v16, v11
    v_add_f32 v18, v18, v19
    v_cos_f32 v25, v16
    v_sin_f32 v29, v18
    v_add_f32 v16, v16, v11
    v_add_f32 v18, v18, v19
    v_cos_f32 v26, v16
    v_sin_f32 v30, v18
    v_add_f32 v16, v16, v11
    v_add_f32 v18, v18, v19
    v_cos_f32 v27, v16
    v_sin_f32 v31, v18
    v_add_f32 v16, v16, v11
    v_add_f32 v18, v18, v19
    v_cvt_pk_bf16_f32 v146, v24, v26
    v_cvt_pk_bf16_f32 v150, v25, v27
    v_cvt_pk_bf16_f32 v210, v28, v30
    v_cvt_pk_bf16_f32 v214, v29, v31
    v_cos_f32 v24, v16
    v_sin_f32 v28, v18
    v_add_f32 v16, v16, v11
    v_add_f32 v18, v18, v19
    v_cos_f32 v25, v16
    v_sin_f32 v29, v18
    v_add_f32 v16, v16, v11
    v_add_f32 v18, v18, v19
    v_cos_f32 v26, v16
    v_sin_f32 v30, v18
    v_add_f32 v16, v16, v11
    v_add_f32 v18, v18, v19
    v_cos_f32 v27, v16
    v_sin_f32 v31, v18
    v_add_f32 v16, v16, v11
    v_add_f32 v18, v18, v19
    v_cvt_pk_bf16_f32 v147, v24, v26
    v_cvt_pk_bf16_f32 v151, v25, v27
    v_cvt_pk_bf16_f32 v211, v28, v30
    v_cvt_pk_bf16_f32 v215, v29, v31
    v_add_f32 v16, v16, v17
    v_add_f32 v18, v18, v20
    v_cos_f32 v24, v16
    v_sin_f32 v28, v18
    v_add_f32 v16, v16, v11
    v_add_f32 v18, v18, v19
    v_cos_f32 v25, v16
    v_sin_f32 v29, v18
    v_add_f32 v16, v16, v11
    v_add_f32 v18, v18, v19
    v_cos_f32 v26, v16
    v_sin_f32 v30, v18
    v_add_f32 v16, v16, v11
    v_add_f32 v18, v18, v19
    v_cos_f32 v27, v16
    v_sin_f32 v31, v18
    v_add_f32 v16, v16, v11
    v_add_f32 v18, v18, v19
    v_cvt_pk_bf16_f32 v152, v24, v26
    v_cvt_pk_bf16_f32 v156, v25, v27
    v_cvt_pk_bf16_f32 v216, v28, v30
    v_cvt_pk_bf16_f32 v220, v29, v31
    v_cos_f32 v24, v16
    v_sin_f32 v28, v18
    v_add_f32 v16, v16, v11
    v_add_f32 v18, v18, v19
    v_cos_f32 v25, v16
    v_sin_f32 v29, v18
    v_add_f32 v16, v16, v11
    v_add_f32 v18, v18, v19
    v_cos_f32 v26, v16
    v_sin_f32 v30, v18
    v_add_f32 v16, v16, v11
    v_add_f32 v18, v18, v19
    v_cos_f32 v27, v16
    v_sin_f32 v31, v18
    v_add_f32 v16, v16, v11
    v_add_f32 v18, v18, v19
    v_cvt_pk_bf16_f32 v153, v24, v26
    v_cvt_pk_bf16_f32 v157, v25, v27
    v_cvt_pk_bf16_f32 v217, v28, v30
    v_cvt_pk_bf16_f32 v221, v29, v31
    v_cos_f32 v24, v16
    v_sin_f32 v28, v18
    v_add_f32 v16, v16, v11
    v_add_f32 v18, v18, v19
    v_cos_f32 v25, v16
    v_sin_f32 v29, v18
    v_add_f32 v16, v16, v11
    v_add_f32 v18, v18, v19
    v_cos_f32 v26, v16
    v_sin_f32 v30, v18
    v_add_f32 v16, v16, v11
    v_add_f32 v18, v18, v19
    v_cos_f32 v27, v16
    v_sin_f32 v31, v18
    v_add_f32 v16, v16, v11
    v_add_f32 v18, v18, v19
    v_cvt_pk_bf16_f32 v154, v24, v26
    v_cvt_pk_bf16_f32 v158, v25, v27
    v_cvt_pk_bf16_f32 v218, v28, v30
    v_cvt_pk_bf16_f32 v222, v29, v31
    v_cos_f32 v24, v16
    v_sin_f32 v28, v18
    v_add_f32 v16, v16, v11
    v_add_f32 v18, v18, v19
    v_cos_f32 v25, v16
    v_sin_f32 v29, v18
    v_add_f32 v16, v16, v11
    v_add_f32 v18, v18, v19
    v_cos_f32 v26, v16
    v_sin_f32 v30, v18
    v_add_f32 v16, v16, v11
    v_add_f32 v18, v18, v19
    v_cos_f32 v27, v16
    v_sin_f32 v31, v18
    v_add_f32 v16, v16, v11
    v_add_f32 v18, v18, v19
    v_cvt_pk_bf16_f32 v155, v24, v26
    v_cvt_pk_bf16_f32 v159, v25, v27
    v_cvt_pk_bf16_f32 v219, v28, v30
    v_cvt_pk_bf16_f32 v223, v29, v31
    v_add_f32 v16, v16, v17
    v_add_f32 v18, v18, v20
    buffer_load_dword v254, v253, s[12:15], s76 offen
    s_add_u32 s76, s76, 128
    v_cos_f32 v24, v16
    v_sin_f32 v28, v18
    v_add_f32 v16, v16, v11
    v_add_f32 v18, v18, v19
    v_cos_f32 v25, v16
    v_sin_f32 v29, v18
    v_add_f32 v16, v16, v11
    v_add_f32 v18, v18, v19
    v_cos_f32 v26, v16
    v_sin_f32 v30, v18
    v_add_f32 v16, v16, v11
    v_add_f32 v18, v18, v19
    v_cos_f32 v27, v16
    v_sin_f32 v31, v18
    v_add_f32 v16, v16, v11
    v_add_f32 v18, v18, v19
    v_cvt_pk_bf16_f32 v160, v24, v26
    v_cvt_pk_bf16_f32 v164, v25, v27
    v_cvt_pk_bf16_f32 v224, v28, v30
    v_cvt_pk_bf16_f32 v228, v29, v31
    v_cos_f32 v24, v16
    v_sin_f32 v28, v18
    v_add_f32 v16, v16, v11
    v_add_f32 v18, v18, v19
    v_cos_f32 v25, v16
    v_sin_f32 v29, v18
    v_add_f32 v16, v16, v11
    v_add_f32 v18, v18, v19
    v_cos_f32 v26, v16
    v_sin_f32 v30, v18
    v_add_f32 v16, v16, v11
    v_add_f32 v18, v18, v19
    v_cos_f32 v27, v16
    v_sin_f32 v31, v18
    v_add_f32 v16, v16, v11
    v_add_f32 v18, v18, v19
    v_cvt_pk_bf16_f32 v161, v24, v26
    v_cvt_pk_bf16_f32 v165, v25, v27
    v_cvt_pk_bf16_f32 v225, v28, v30
    v_cvt_pk_bf16_f32 v229, v29, v31
    v_cos_f32 v24, v16
    v_sin_f32 v28, v18
    v_add_f32 v16, v16, v11
    v_add_f32 v18, v18, v19
    v_cos_f32 v25, v16
    v_sin_f32 v29, v18
    v_add_f32 v16, v16, v11
    v_add_f32 v18, v18, v19
    v_cos_f32 v26, v16
    v_sin_f32 v30, v18
    v_add_f32 v16, v16, v11
    v_add_f32 v18, v18, v19
    v_cos_f32 v27, v16
    v_sin_f32 v31, v18
    v_add_f32 v16, v16, v11
    v_add_f32 v18, v18, v19
    v_cvt_pk_bf16_f32 v162, v24, v26
    v_cvt_pk_bf16_f32 v166, v25, v27
    v_cvt_pk_bf16_f32 v226, v28, v30
    v_cvt_pk_bf16_f32 v230, v29, v31
    v_cos_f32 v24, v16
    v_sin_f32 v28, v18
    v_add_f32 v16, v16, v11
    v_add_f32 v18, v18, v19
    v_cos_f32 v25, v16
    v_sin_f32 v29, v18
    v_add_f32 v16, v16, v11
    v_add_f32 v18, v18, v19
    v_cos_f32 v26, v16
    v_sin_f32 v30, v18
    v_add_f32 v16, v16, v11
    v_add_f32 v18, v18, v19
    v_cos_f32 v27, v16
    v_sin_f32 v31, v18
    v_add_f32 v16, v16, v11
    v_add_f32 v18, v18, v19
    v_cvt_pk_bf16_f32 v163, v24, v26
    v_cvt_pk_bf16_f32 v167, v25, v27
    v_cvt_pk_bf16_f32 v227, v28, v30
    v_cvt_pk_bf16_f32 v231, v29, v31
    v_add_f32 v16, v16, v17
    v_add_f32 v18, v18, v20
    v_cos_f32 v24, v16
    v_sin_f32 v28, v18
    v_add_f32 v16, v16, v11
    v_add_f32 v18, v18, v19
    v_cos_f32 v25, v16
    v_sin_f32 v29, v18
    v_add_f32 v16, v16, v11
    v_add_f32 v18, v18, v19
    v_cos_f32 v26, v16
    v_sin_f32 v30, v18
    v_add_f32 v16, v16, v11
    v_add_f32 v18, v18, v19
    v_cos_f32 v27, v16
    v_sin_f32 v31, v18
    v_add_f32 v16, v16, v11
    v_add_f32 v18, v18, v19
    v_cvt_pk_bf16_f32 v168, v24, v26
    v_cvt_pk_bf16_f32 v172, v25, v27
    v_cvt_pk_bf16_f32 v232, v28, v30
    v_cvt_pk_bf16_f32 v236, v29, v31
    v_cos_f32 v24, v16
    v_sin_f32 v28, v18
    v_add_f32 v16, v16, v11
    v_add_f32 v18, v18, v19
    v_cos_f32 v25, v16
    v_sin_f32 v29, v18
    v_add_f32 v16, v16, v11
    v_add_f32 v18, v18, v19
    v_cos_f32 v26, v16
    v_sin_f32 v30, v18
    v_add_f32 v16, v16, v11
    v_add_f32 v18, v18, v19
    v_cos_f32 v27, v16
    v_sin_f32 v31, v18
    v_add_f32 v16, v16, v11
    v_add_f32 v18, v18, v19
    v_cvt_pk_bf16_f32 v169, v24, v26
    v_cvt_pk_bf16_f32 v173, v25, v27
    v_cvt_pk_bf16_f32 v233, v28, v30
    v_cvt_pk_bf16_f32 v237, v29, v31
    v_cos_f32 v24, v16
    v_sin_f32 v28, v18
    v_add_f32 v16, v16, v11
    v_add_f32 v18, v18, v19
    v_cos_f32 v25, v16
    v_sin_f32 v29, v18
    v_add_f32 v16, v16, v11
    v_add_f32 v18, v18, v19
    v_cos_f32 v26, v16
    v_sin_f32 v30, v18
    v_add_f32 v16, v16, v11
    v_add_f32 v18, v18, v19
    v_cos_f32 v27, v16
    v_sin_f32 v31, v18
    v_add_f32 v16, v16, v11
    v_add_f32 v18, v18, v19
    v_cvt_pk_bf16_f32 v170, v24, v26
    v_cvt_pk_bf16_f32 v174, v25, v27
    v_cvt_pk_bf16_f32 v234, v28, v30
    v_cvt_pk_bf16_f32 v238, v29, v31
    v_cos_f32 v24, v16
    v_sin_f32 v28, v18
    v_add_f32 v16, v16, v11
    v_add_f32 v18, v18, v19
    v_cos_f32 v25, v16
    v_sin_f32 v29, v18
    v_add_f32 v16, v16, v11
    v_add_f32 v18, v18, v19
    v_cos_f32 v26, v16
    v_sin_f32 v30, v18
    v_add_f32 v16, v16, v11
    v_add_f32 v18, v18, v19
    v_cos_f32 v27, v16
    v_sin_f32 v31, v18
    v_add_f32 v16, v16, v11
    v_add_f32 v18, v18, v19
    v_cvt_pk_bf16_f32 v171, v24, v26
    v_cvt_pk_bf16_f32 v175, v25, v27
    v_cvt_pk_bf16_f32 v235, v28, v30
    v_cvt_pk_bf16_f32 v239, v29, v31
    v_add_f32 v16, v16, v17
    v_add_f32 v18, v18, v20
    v_cos_f32 v24, v16
    v_sin_f32 v28, v18
    v_add_f32 v16, v16, v11
    v_add_f32 v18, v18, v19
    v_cos_f32 v25, v16
    v_sin_f32 v29, v18
    v_add_f32 v16, v16, v11
    v_add_f32 v18, v18, v19
    v_cos_f32 v26, v16
    v_sin_f32 v30, v18
    v_add_f32 v16, v16, v11
    v_add_f32 v18, v18, v19
    v_cos_f32 v27, v16
    v_sin_f32 v31, v18
    v_add_f32 v16, v16, v11
    v_add_f32 v18, v18, v19
    v_cvt_pk_bf16_f32 v176, v24, v26
    v_cvt_pk_bf16_f32 v180, v25, v27
    v_cvt_pk_bf16_f32 v240, v28, v30
    v_cvt_pk_bf16_f32 v244, v29, v31
    v_cos_f32 v24, v16
    v_sin_f32 v28, v18
    v_add_f32 v16, v16, v11
    v_add_f32 v18, v18, v19
    v_cos_f32 v25, v16
    v_sin_f32 v29, v18
    v_add_f32 v16, v16, v11
    v_add_f32 v18, v18, v19
    v_cos_f32 v26, v16
    v_sin_f32 v30, v18
    v_add_f32 v16, v16, v11
    v_add_f32 v18, v18, v19
    v_cos_f32 v27, v16
    v_sin_f32 v31, v18
    v_add_f32 v16, v16, v11
    v_add_f32 v18, v18, v19
    v_cvt_pk_bf16_f32 v177, v24, v26
    v_cvt_pk_bf16_f32 v181, v25, v27
    v_cvt_pk_bf16_f32 v241, v28, v30
    v_cvt_pk_bf16_f32 v245, v29, v31
    v_cos_f32 v24, v16
    v_sin_f32 v28, v18
    v_add_f32 v16, v16, v11
    v_add_f32 v18, v18, v19
    v_cos_f32 v25, v16
    v_sin_f32 v29, v18
    v_add_f32 v16, v16, v11
    v_add_f32 v18, v18, v19
    v_cos_f32 v26, v16
    v_sin_f32 v30, v18
    v_add_f32 v16, v16, v11
    v_add_f32 v18, v18, v19
    v_cos_f32 v27, v16
    v_sin_f32 v31, v18
    v_add_f32 v16, v16, v11
    v_add_f32 v18, v18, v19
    v_cvt_pk_bf16_f32 v178, v24, v26
    v_cvt_pk_bf16_f32 v182, v25, v27
    v_cvt_pk_bf16_f32 v242, v28, v30
    v_cvt_pk_bf16_f32 v246, v29, v31
    v_cos_f32 v24, v16
    v_sin_f32 v28, v18
    v_add_f32 v16, v16, v11
    v_add_f32 v18, v18, v19
    v_cos_f32 v25, v16
    v_sin_f32 v29, v18
    v_add_f32 v16, v16, v11
    v_add_f32 v18, v18, v19
    v_cos_f32 v26, v16
    v_sin_f32 v30, v18
    v_add_f32 v16, v16, v11
    v_add_f32 v18, v18, v19
    v_cos_f32 v27, v16
    v_sin_f32 v31, v18
    v_add_f32 v16, v16, v11
    v_add_f32 v18, v18, v19
    v_cvt_pk_bf16_f32 v179, v24, v26
    v_cvt_pk_bf16_f32 v183, v25, v27
    v_cvt_pk_bf16_f32 v243, v28, v30
    v_cvt_pk_bf16_f32 v247, v29, v31
    v_add_f32 v16, v16, v17
    v_add_f32 v18, v18, v20
    buffer_load_dword v254, v253, s[12:15], s76 offen
    s_add_u32 s76, s76, 128
    v_bfi_b32 v184, v8, v9, v184
    s_cmp_eq_u32 s63, 1
    s_cbranch_scc1 L_trigdone
    v_accvgpr_write_b32 a0, v120
    v_accvgpr_write_b32 a1, v121
    v_accvgpr_write_b32 a2, v122
    v_accvgpr_write_b32 a3, v123
    v_accvgpr_write_b32 a4, v124
    v_accvgpr_write_b32 a5, v125
    v_accvgpr_write_b32 a6, v126
    v_accvgpr_write_b32 a7, v127
    v_accvgpr_write_b32 a8, v128
    v_accvgpr_write_b32 a9, v129
    v_accvgpr_write_b32 a10, v130
    v_accvgpr_write_b32 a11, v131
    v_accvgpr_write_b32 a12, v132
    v_accvgpr_write_b32 a13, v133
    v_accvgpr_write_b32 a14, v134
    v_accvgpr_write_b32 a15, v135
    v_accvgpr_write_b32 a16, v136
    v_accvgpr_write_b32 a17, v137
    v_accvgpr_write_b32 a18, v138
    v_accvgpr_write_b32 a19, v139
    v_accvgpr_write_b32 a20, v140
    v_accvgpr_write_b32 a21, v141
    v_accvgpr_write_b32 a22, v142
    v_accvgpr_write_b32 a23, v143
    v_accvgpr_write_b32 a24, v144
    v_accvgpr_write_b32 a25, v145
    v_accvgpr_write_b32 a26, v146
    v_accvgpr_write_b32 a27, v147
    v_accvgpr_write_b32 a28, v148
    v_accvgpr_write_b32 a29, v149
    v_accvgpr_write_b32 a30, v150
    v_accvgpr_write_b32 a31, v151
    v_accvgpr_write_b32 a32, v152
    v_accvgpr_write_b32 a33, v153
    v_accvgpr_write_b32 a34, v154
    v_accvgpr_write_b32 a35, v155
    v_accvgpr_write_b32 a36, v156
    v_accvgpr_write_b32 a37, v157
    v_accvgpr_write_b32 a38, v158
    v_accvgpr_write_b32 a39, v159
    v_accvgpr_write_b32 a40, v160
    v_accvgpr_write_b32 a41, v161
    v_accvgpr_write_b32 a42, v162
    v_accvgpr_write_b32 a43, v163
    v_accvgpr_write_b32 a44, v164
    v_accvgpr_write_b32 a45, v165
    v_accvgpr_write_b32 a46, v166
    v_accvgpr_write_b32 a47, v167
    v_accvgpr_write_b32 a48, v168
    v_accvgpr_write_b32 a49, v169
    v_accvgpr_write_b32 a50, v170
    v_accvgpr_write_b32 a51, v171
    v_accvgpr_write_b32 a52, v172
    v_accvgpr_write_b32 a53, v173
    v_accvgpr_write_b32 a54, v174
    v_accvgpr_write_b32 a55, v175
    v_accvgpr_write_b32 a56, v176
    v_accvgpr_write_b32 a57, v177
    v_accvgpr_write_b32 a58, v178
    v_accvgpr_write_b32 a59, v179
    v_accvgpr_write_b32 a60, v180
    v_accvgpr_write_b32 a61, v181
    v_accvgpr_write_b32 a62, v182
    v_accvgpr_write_b32 a63, v183
    v_accvgpr_write_b32 a64, v184
    v_accvgpr_write_b32 a65, v185
    v_accvgpr_write_b32 a66, v186
    v_accvgpr_write_b32 a67, v187
    v_accvgpr_write_b32 a68, v188
    v_accvgpr_write_b32 a69, v189
    v_accvgpr_write_b32 a70, v190
    v_accvgpr_write_b32 a71, v191
    v_accvgpr_write_b32 a72, v192
    v_accvgpr_write_b32 a73, v193
    v_accvgpr_write_b32 a74, v194
    v_accvgpr_write_b32 a75, v195
    v_accvgpr_write_b32 a76, v196
    v_accvgpr_write_b32 a77, v197
    v_accvgpr_write_b32 a78, v198
    v_accvgpr_write_b32 a79, v199
    v_accvgpr_write_b32 a80, v200
    v_accvgpr_write_b32 a81, v201
    v_accvgpr_write_b32 a82, v202
    v_accvgpr_write_b32 a83, v203
    v_accvgpr_write_b32 a84, v204
    v_accvgpr_write_b32 a85, v205
    v_accvgpr_write_b32 a86, v206
    v_accvgpr_write_b32 a87, v207
    v_accvgpr_write_b32 a88, v208
    v_accvgpr_write_b32 a89, v209
    v_accvgpr_write_b32 a90, v210
    v_accvgpr_write_b32 a91, v211
    v_accvgpr_write_b32 a92, v212
    v_accvgpr_write_b32 a93, v213
    v_accvgpr_write_b32 a94, v214
    v_accvgpr_write_b32 a95, v215
    v_accvgpr_write_b32 a96, v216
    v_accvgpr_write_b32 a97, v217
    v_accvgpr_write_b32 a98, v218
    v_accvgpr_write_b32 a99, v219
    v_accvgpr_write_b32 a100, v220
    v_accvgpr_write_b32 a101, v221
    v_accvgpr_write_b32 a102, v222
    v_accvgpr_write_b32 a103, v223
    v_accvgpr_write_b32 a104, v224
    v_accvgpr_write_b32 a105, v225
    v_accvgpr_write_b32 a106, v226
    v_accvgpr_write_b32 a107, v227
    v_accvgpr_write_b32 a108, v228
    v_accvgpr_write_b32 a109, v229
    v_accvgpr_write_b32 a110, v230
    v_accvgpr_write_b32 a111, v231
    v_accvgpr_write_b32 a112, v232
    v_accvgpr_write_b32 a113, v233
    v_accvgpr_write_b32 a114, v234
    v_accvgpr_write_b32 a115, v235
    v_accvgpr_write_b32 a116, v236
    v_accvgpr_write_b32 a117, v237
    v_accvgpr_write_b32 a118, v238
    v_accvgpr_write_b32 a119, v239
    v_accvgpr_write_b32 a120, v240
    v_accvgpr_write_b32 a121, v241
    v_accvgpr_write_b32 a122, v242
    v_accvgpr_write_b32 a123, v243
    v_accvgpr_write_b32 a124, v244
    v_accvgpr_write_b32 a125, v245
    v_accvgpr_write_b32 a126, v246
    v_accvgpr_write_b32 a127, v247
    v_mov_b32 v11, v10
    v_mul_f32 v16, v7, v10
    v_mul_f32 v17, 0x42400000, v10
    s_mov_b32 s63, 1
    s_branch L_trig
L_trigdone:
    v_and_b32 v4, 7, v1
    v_lshlrev_b32 v32, 4, v4
    v_bfe_u32 v33, v1, 3, 2
    v_lshrrev_b32 v34, 5, v1
    s_lshl_b32 s70, s64, 2
    s_add_u32 s70, s70, s3
    s_lshl_b32 s70, s70, 1
    v_add_u32 v34, s70, v34
    s_movk_i32 s67, 1152
    v_mov_b32 v35, 1073741824
    buffer_load_dwordx4 v[44:47], v32, s[24:27], 0 offen offset:0
    buffer_load_dwordx4 v[48:51], v32, s[24:27], 0 offen offset:128
    buffer_load_dwordx4 v[52:55], v32, s[24:27], 0 offen offset:256
    buffer_load_dwordx4 v[56:59], v32, s[24:27], 0 offen offset:384
    buffer_load_dwordx4 v[60:63], v32, s[24:27], 0 offen offset:512
    buffer_load_dwordx4 v[64:67], v32, s[24:27], 0 offen offset:640
    buffer_load_dwordx4 v[68:71], v32, s[24:27], 0 offen offset:768
    buffer_load_dwordx4 v[72:75], v32, s[24:27], 0 offen offset:896
    buffer_load_dwordx4 v[76:79], v32, s[24:27], 0 offen offset:1024
    v_cmp_eq_u32 vcc, 0, v34
    v_mov_b32 v37, 512
    v_add_u32 v38, 1, v33
    v_cndmask_b32 v37, v34, v37, vcc
    v_cmp_lt_u32 vcc, 1, v33
    v_sub_u32 v37, 0, v37
    v_lshrrev_b32 v38, 1, v38
    v_cndmask_b32 v37, v34, v37, vcc
    v_lshl_add_u32 v36, v38, 10, v37
    v_cmp_gt_u32 vcc, 512, v34
    v_mad_u32_u24 v36, v36, s67, v32
    v_lshl_add_u32 v37, v34, 2, v33
    v_cndmask_b32 v36, v35, v36, vcc
    v_lshlrev_b32 v37, 2, v37
    v_cndmask_b32 v20, v35, v37, vcc
    v_add_u32 v34, 160, v34
    buffer_load_dwordx4 v[80:83], v36, s[20:23], 0 offen offset:0
    buffer_load_dwordx4 v[84:87], v36, s[20:23], 0 offen offset:128
    buffer_load_dwordx4 v[88:91], v36, s[20:23], 0 offen offset:256
    buffer_load_dwordx4 v[92:95], v36, s[20:23], 0 offen offset:384
    buffer_load_dwordx4 v[96:99], v36, s[20:23], 0 offen offset:512
    buffer_load_dwordx4 v[100:103], v36, s[20:23], 0 offen offset:640
    buffer_load_dwordx4 v[104:107], v36, s[20:23], 0 offen offset:768
    buffer_load_dwordx4 v[108:111], v36, s[20:23], 0 offen offset:896
    buffer_load_dwordx4 v[112:115], v36, s[20:23], 0 offen offset:1024
    v_cmp_eq_u32 vcc, 0, v34
    v_mov_b32 v37, 512
    v_add_u32 v38, 1, v33
    v_cndmask_b32 v37, v34, v37, vcc
    v_cmp_lt_u32 vcc, 1, v33
    v_sub_u32 v37, 0, v37
    v_lshrrev_b32 v38, 1, v38
    v_cndmask_b32 v37, v34, v37, vcc
    v_lshl_add_u32 v36, v38, 10, v37
    v_cmp_gt_u32 vcc, 512, v34
    v_mad_u32_u24 v36, v36, s67, v32
    v_lshl_add_u32 v37, v34, 2, v33
    v_cndmask_b32 v36, v35, v36, vcc
    v_lshlrev_b32 v37, 2, v37
    v_cndmask_b32 v21, v35, v37, vcc
    v_add_u32 v34, 160, v34
    buffer_load_dwordx4 a[128:131], v36, s[20:23], 0 offen offset:0
    buffer_load_dwordx4 a[132:135], v36, s[20:23], 0 offen offset:128
    buffer_load_dwordx4 a[136:139], v36, s[20:23], 0 offen offset:256
    buffer_load_dwordx4 a[140:143], v36, s[20:23], 0 offen offset:384
    buffer_load_dwordx4 a[144:147], v36, s[20:23], 0 offen offset:512
    buffer_load_dwordx4 a[148:151], v36, s[20:23], 0 offen offset:640
    buffer_load_dwordx4 a[152:155], v36, s[20:23], 0 offen offset:768
    buffer_load_dwordx4 a[156:159], v36, s[20:23], 0 offen offset:896
    buffer_load_dwordx4 a[160:163], v36, s[20:23], 0 offen offset:1024
    v_cmp_eq_u32 vcc, 0, v34
    v_mov_b32 v37, 512
    v_add_u32 v38, 1, v33
    v_cndmask_b32 v37, v34, v37, vcc
    v_cmp_lt_u32 vcc, 1, v33
    v_sub_u32 v37, 0, v37
    v_lshrrev_b32 v38, 1, v38
    v_cndmask_b32 v37, v34, v37, vcc
    v_lshl_add_u32 v36, v38, 10, v37
    v_cmp_gt_u32 vcc, 512, v34
    v_mad_u32_u24 v36, v36, s67, v32
    v_lshl_add_u32 v37, v34, 2, v33
    v_cndmask_b32 v36, v35, v36, vcc
    v_lshlrev_b32 v37, 2, v37
    v_cndmask_b32 v22, v35, v37, vcc
    v_add_u32 v34, 160, v34
    buffer_load_dwordx4 a[164:167], v36, s[20:23], 0 offen offset:0
    buffer_load_dwordx4 a[168:171], v36, s[20:23], 0 offen offset:128
    buffer_load_dwordx4 a[172:175], v36, s[20:23], 0 offen offset:256
    buffer_load_dwordx4 a[176:179], v36, s[20:23], 0 offen offset:384
    buffer_load_dwordx4 a[180:183], v36, s[20:23], 0 offen offset:512
    buffer_load_dwordx4 a[184:187], v36, s[20:23], 0 offen offset:640
    buffer_load_dwordx4 a[188:191], v36, s[20:23], 0 offen offset:768
    buffer_load_dwordx4 a[192:195], v36, s[20:23], 0 offen offset:896
    buffer_load_dwordx4 a[196:199], v36, s[20:23], 0 offen offset:1024
    v_cmp_eq_u32 vcc, 0, v34
    v_mov_b32 v37, 512
    v_add_u32 v38, 1, v33
    v_cndmask_b32 v37, v34, v37, vcc
    v_cmp_lt_u32 vcc, 1, v33
    v_sub_u32 v37, 0, v37
    v_lshrrev_b32 v38, 1, v38
    v_cndmask_b32 v37, v34, v37, vcc
    v_lshl_add_u32 v36, v38, 10, v37
    v_cmp_gt_u32 vcc, 512, v34
    v_mad_u32_u24 v36, v36, s67, v32
    v_lshl_add_u32 v37, v34, 2, v33
    v_cndmask_b32 v36, v35, v36, vcc
    v_lshlrev_b32 v37, 2, v37
    v_cndmask_b32 v23, v35, v37, vcc
    v_add_u32 v34, 160, v34
    buffer_load_dwordx4 a[200:203], v36, s[20:23], 0 offen offset:0
    buffer_load_dwordx4 a[204:207], v36, s[20:23], 0 offen offset:128
    buffer_load_dwordx4 a[208:211], v36, s[20:23], 0 offen offset:256
    buffer_load_dwordx4 a[212:215], v36, s[20:23], 0 offen offset:384
    buffer_load_dwordx4 a[216:219], v36, s[20:23], 0 offen offset:512
    buffer_load_dwordx4 a[220:223], v36, s[20:23], 0 offen offset:640
    buffer_load_dwordx4 a[224:227], v36, s[20:23], 0 offen offset:768
    buffer_load_dwordx4 a[228:231], v36, s[20:23], 0 offen offset:896
    buffer_load_dwordx4 a[232:235], v36, s[20:23], 0 offen offset:1024
    v_mov_b32 v24, 0
    v_mov_b32 v28, 0
    s_waitcnt vmcnt(27)
    v_dot2_f32_bf16 v24, v80, v44, v24
    v_dot2_f32_bf16 v28, v81, v45, v28
    v_dot2_f32_bf16 v24, v82, v46, v24
    v_dot2_f32_bf16 v28, v83, v47, v28
    v_dot2_f32_bf16 v24, v84, v48, v24
    v_dot2_f32_bf16 v28, v85, v49, v28
    v_dot2_f32_bf16 v24, v86, v50, v24
    v_dot2_f32_bf16 v28, v87, v51, v28
    v_dot2_f32_bf16 v24, v88, v52, v24
    v_dot2_f32_bf16 v28, v89, v53, v28
    v_dot2_f32_bf16 v24, v90, v54, v24
    v_dot2_f32_bf16 v28, v91, v55, v28
    v_dot2_f32_bf16 v24, v92, v56, v24
    v_dot2_f32_bf16 v28, v93, v57, v28
    v_dot2_f32_bf16 v24, v94, v58, v24
    v_dot2_f32_bf16 v28, v95, v59, v28
    v_dot2_f32_bf16 v24, v96, v60, v24
    v_dot2_f32_bf16 v28, v97, v61, v28
    v_dot2_f32_bf16 v24, v98, v62, v24
    v_dot2_f32_bf16 v28, v99, v63, v28
    v_dot2_f32_bf16 v24, v100, v64, v24
    v_dot2_f32_bf16 v28, v101, v65, v28
    v_dot2_f32_bf16 v24, v102, v66, v24
    v_dot2_f32_bf16 v28, v103, v67, v28
    v_dot2_f32_bf16 v24, v104, v68, v24
    v_dot2_f32_bf16 v28, v105, v69, v28
    v_dot2_f32_bf16 v24, v106, v70, v24
    v_dot2_f32_bf16 v28, v107, v71, v28
    v_dot2_f32_bf16 v24, v108, v72, v24
    v_dot2_f32_bf16 v28, v109, v73, v28
    v_dot2_f32_bf16 v24, v110, v74, v24
    v_dot2_f32_bf16 v28, v111, v75, v28
    v_dot2_f32_bf16 v24, v112, v76, v24
    v_dot2_f32_bf16 v28, v113, v77, v28
    v_dot2_f32_bf16 v24, v114, v78, v24
    v_dot2_f32_bf16 v28, v115, v79, v28
    s_nop 2
    v_add_f32 v24, v24, v28
    v_mov_b32 v25, 0
    v_mov_b32 v28, 0
    s_waitcnt vmcnt(18)
    v_accvgpr_read_b32 v80, a128
    v_accvgpr_read_b32 v81, a129
    v_accvgpr_read_b32 v82, a130
    v_accvgpr_read_b32 v83, a131
    v_accvgpr_read_b32 v84, a132
    v_accvgpr_read_b32 v85, a133
    v_accvgpr_read_b32 v86, a134
    v_accvgpr_read_b32 v87, a135
    v_accvgpr_read_b32 v88, a136
    v_accvgpr_read_b32 v89, a137
    v_accvgpr_read_b32 v90, a138
    v_accvgpr_read_b32 v91, a139
    v_accvgpr_read_b32 v92, a140
    v_accvgpr_read_b32 v93, a141
    v_accvgpr_read_b32 v94, a142
    v_accvgpr_read_b32 v95, a143
    v_accvgpr_read_b32 v96, a144
    v_accvgpr_read_b32 v97, a145
    v_accvgpr_read_b32 v98, a146
    v_accvgpr_read_b32 v99, a147
    v_accvgpr_read_b32 v100, a148
    v_accvgpr_read_b32 v101, a149
    v_accvgpr_read_b32 v102, a150
    v_accvgpr_read_b32 v103, a151
    v_accvgpr_read_b32 v104, a152
    v_accvgpr_read_b32 v105, a153
    v_accvgpr_read_b32 v106, a154
    v_accvgpr_read_b32 v107, a155
    v_accvgpr_read_b32 v108, a156
    v_accvgpr_read_b32 v109, a157
    v_accvgpr_read_b32 v110, a158
    v_accvgpr_read_b32 v111, a159
    v_accvgpr_read_b32 v112, a160
    v_accvgpr_read_b32 v113, a161
    v_accvgpr_read_b32 v114, a162
    v_accvgpr_read_b32 v115, a163
    v_dot2_f32_bf16 v25, v80, v44, v25
    v_dot2_f32_bf16 v28, v81, v45, v28
    v_dot2_f32_bf16 v25, v82, v46, v25
    v_dot2_f32_bf16 v28, v83, v47, v28
    v_dot2_f32_bf16 v25, v84, v48, v25
    v_dot2_f32_bf16 v28, v85, v49, v28
    v_dot2_f32_bf16 v25, v86, v50, v25
    v_dot2_f32_bf16 v28, v87, v51, v28
    v_dot2_f32_bf16 v25, v88, v52, v25
    v_dot2_f32_bf16 v28, v89, v53, v28
    v_dot2_f32_bf16 v25, v90, v54, v25
    v_dot2_f32_bf16 v28, v91, v55, v28
    v_dot2_f32_bf16 v25, v92, v56, v25
    v_dot2_f32_bf16 v28, v93, v57, v28
    v_dot2_f32_bf16 v25, v94, v58, v25
    v_dot2_f32_bf16 v28, v95, v59, v28
    v_dot2_f32_bf16 v25, v96, v60, v25
    v_dot2_f32_bf16 v28, v97, v61, v28
    v_dot2_f32_bf16 v25, v98, v62, v25
    v_dot2_f32_bf16 v28, v99, v63, v28
    v_dot2_f32_bf16 v25, v100, v64, v25
    v_dot2_f32_bf16 v28, v101, v65, v28
    v_dot2_f32_bf16 v25, v102, v66, v25
    v_dot2_f32_bf16 v28, v103, v67, v28
    v_dot2_f32_bf16 v25, v104, v68, v25
    v_dot2_f32_bf16 v28, v105, v69, v28
    v_dot2_f32_bf16 v25, v106, v70, v25
    v_dot2_f32_bf16 v28, v107, v71, v28
    v_dot2_f32_bf16 v25, v108, v72, v25
    v_dot2_f32_bf16 v28, v109, v73, v28
    v_dot2_f32_bf16 v25, v110, v74, v25
    v_dot2_f32_bf16 v28, v111, v75, v28
    v_dot2_f32_bf16 v25, v112, v76, v25
    v_dot2_f32_bf16 v28, v113, v77, v28
    v_dot2_f32_bf16 v25, v114, v78, v25
    v_dot2_f32_bf16 v28, v115, v79, v28
    s_nop 2
    v_add_f32 v25, v25, v28
    v_mov_b32 v26, 0
    v_mov_b32 v28, 0
    s_waitcnt vmcnt(9)
    v_accvgpr_read_b32 v80, a164
    v_accvgpr_read_b32 v81, a165
    v_accvgpr_read_b32 v82, a166
    v_accvgpr_read_b32 v83, a167
    v_accvgpr_read_b32 v84, a168
    v_accvgpr_read_b32 v85, a169
    v_accvgpr_read_b32 v86, a170
    v_accvgpr_read_b32 v87, a171
    v_accvgpr_read_b32 v88, a172
    v_accvgpr_read_b32 v89, a173
    v_accvgpr_read_b32 v90, a174
    v_accvgpr_read_b32 v91, a175
    v_accvgpr_read_b32 v92, a176
    v_accvgpr_read_b32 v93, a177
    v_accvgpr_read_b32 v94, a178
    v_accvgpr_read_b32 v95, a179
    v_accvgpr_read_b32 v96, a180
    v_accvgpr_read_b32 v97, a181
    v_accvgpr_read_b32 v98, a182
    v_accvgpr_read_b32 v99, a183
    v_accvgpr_read_b32 v100, a184
    v_accvgpr_read_b32 v101, a185
    v_accvgpr_read_b32 v102, a186
    v_accvgpr_read_b32 v103, a187
    v_accvgpr_read_b32 v104, a188
    v_accvgpr_read_b32 v105, a189
    v_accvgpr_read_b32 v106, a190
    v_accvgpr_read_b32 v107, a191
    v_accvgpr_read_b32 v108, a192
    v_accvgpr_read_b32 v109, a193
    v_accvgpr_read_b32 v110, a194
    v_accvgpr_read_b32 v111, a195
    v_accvgpr_read_b32 v112, a196
    v_accvgpr_read_b32 v113, a197
    v_accvgpr_read_b32 v114, a198
    v_accvgpr_read_b32 v115, a199
    v_dot2_f32_bf16 v26, v80, v44, v26
    v_dot2_f32_bf16 v28, v81, v45, v28
    v_dot2_f32_bf16 v26, v82, v46, v26
    v_dot2_f32_bf16 v28, v83, v47, v28
    v_dot2_f32_bf16 v26, v84, v48, v26
    v_dot2_f32_bf16 v28, v85, v49, v28
    v_dot2_f32_bf16 v26, v86, v50, v26
    v_dot2_f32_bf16 v28, v87, v51, v28
    v_dot2_f32_bf16 v26, v88, v52, v26
    v_dot2_f32_bf16 v28, v89, v53, v28
    v_dot2_f32_bf16 v26, v90, v54, v26
    v_dot2_f32_bf16 v28, v91, v55, v28
    v_dot2_f32_bf16 v26, v92, v56, v26
    v_dot2_f32_bf16 v28, v93, v57, v28
    v_dot2_f32_bf16 v26, v94, v58, v26
    v_dot2_f32_bf16 v28, v95, v59, v28
    v_dot2_f32_bf16 v26, v96, v60, v26
    v_dot2_f32_bf16 v28, v97, v61, v28
    v_dot2_f32_bf16 v26, v98, v62, v26
    v_dot2_f32_bf16 v28, v99, v63, v28
    v_dot2_f32_bf16 v26, v100, v64, v26
    v_dot2_f32_bf16 v28, v101, v65, v28
    v_dot2_f32_bf16 v26, v102, v66, v26
    v_dot2_f32_bf16 v28, v103, v67, v28
    v_dot2_f32_bf16 v26, v104, v68, v26
    v_dot2_f32_bf16 v28, v105, v69, v28
    v_dot2_f32_bf16 v26, v106, v70, v26
    v_dot2_f32_bf16 v28, v107, v71, v28
    v_dot2_f32_bf16 v26, v108, v72, v26
    v_dot2_f32_bf16 v28, v109, v73, v28
    v_dot2_f32_bf16 v26, v110, v74, v26
    v_dot2_f32_bf16 v28, v111, v75, v28
    v_dot2_f32_bf16 v26, v112, v76, v26
    v_dot2_f32_bf16 v28, v113, v77, v28
    v_dot2_f32_bf16 v26, v114, v78, v26
    v_dot2_f32_bf16 v28, v115, v79, v28
    s_nop 2
    v_add_f32 v26, v26, v28
    v_mov_b32 v27, 0
    v_mov_b32 v28, 0
    s_waitcnt vmcnt(0)
    v_accvgpr_read_b32 v80, a200
    v_accvgpr_read_b32 v81, a201
    v_accvgpr_read_b32 v82, a202
    v_accvgpr_read_b32 v83, a203
    v_accvgpr_read_b32 v84, a204
    v_accvgpr_read_b32 v85, a205
    v_accvgpr_read_b32 v86, a206
    v_accvgpr_read_b32 v87, a207
    v_accvgpr_read_b32 v88, a208
    v_accvgpr_read_b32 v89, a209
    v_accvgpr_read_b32 v90, a210
    v_accvgpr_read_b32 v91, a211
    v_accvgpr_read_b32 v92, a212
    v_accvgpr_read_b32 v93, a213
    v_accvgpr_read_b32 v94, a214
    v_accvgpr_read_b32 v95, a215
    v_accvgpr_read_b32 v96, a216
    v_accvgpr_read_b32 v97, a217
    v_accvgpr_read_b32 v98, a218
    v_accvgpr_read_b32 v99, a219
    v_accvgpr_read_b32 v100, a220
    v_accvgpr_read_b32 v101, a221
    v_accvgpr_read_b32 v102, a222
    v_accvgpr_read_b32 v103, a223
    v_accvgpr_read_b32 v104, a224
    v_accvgpr_read_b32 v105, a225
    v_accvgpr_read_b32 v106, a226
    v_accvgpr_read_b32 v107, a227
    v_accvgpr_read_b32 v108, a228
    v_accvgpr_read_b32 v109, a229
    v_accvgpr_read_b32 v110, a230
    v_accvgpr_read_b32 v111, a231
    v_accvgpr_read_b32 v112, a232
    v_accvgpr_read_b32 v113, a233
    v_accvgpr_read_b32 v114, a234
    v_accvgpr_read_b32 v115, a235
    v_dot2_f32_bf16 v27, v80, v44, v27
    v_dot2_f32_bf16 v28, v81, v45, v28
    v_dot2_f32_bf16 v27, v82, v46, v27
    v_dot2_f32_bf16 v28, v83, v47, v28
    v_dot2_f32_bf16 v27, v84, v48, v27
    v_dot2_f32_bf16 v28, v85, v49, v28
    v_dot2_f32_bf16 v27, v86, v50, v27
    v_dot2_f32_bf16 v28, v87, v51, v28
    v_dot2_f32_bf16 v27, v88, v52, v27
    v_dot2_f32_bf16 v28, v89, v53, v28
    v_dot2_f32_bf16 v27, v90, v54, v27
    v_dot2_f32_bf16 v28, v91, v55, v28
    v_dot2_f32_bf16 v27, v92, v56, v27
    v_dot2_f32_bf16 v28, v93, v57, v28
    v_dot2_f32_bf16 v27, v94, v58, v27
    v_dot2_f32_bf16 v28, v95, v59, v28
    v_dot2_f32_bf16 v27, v96, v60, v27
    v_dot2_f32_bf16 v28, v97, v61, v28
    v_dot2_f32_bf16 v27, v98, v62, v27
    v_dot2_f32_bf16 v28, v99, v63, v28
    v_dot2_f32_bf16 v27, v100, v64, v27
    v_dot2_f32_bf16 v28, v101, v65, v28
    v_dot2_f32_bf16 v27, v102, v66, v27
    v_dot2_f32_bf16 v28, v103, v67, v28
    v_dot2_f32_bf16 v27, v104, v68, v27
    v_dot2_f32_bf16 v28, v105, v69, v28
    v_dot2_f32_bf16 v27, v106, v70, v27
    v_dot2_f32_bf16 v28, v107, v71, v28
    v_dot2_f32_bf16 v27, v108, v72, v27
    v_dot2_f32_bf16 v28, v109, v73, v28
    v_dot2_f32_bf16 v27, v110, v74, v27
    v_dot2_f32_bf16 v28, v111, v75, v28
    v_dot2_f32_bf16 v27, v112, v76, v27
    v_dot2_f32_bf16 v28, v113, v77, v28
    v_dot2_f32_bf16 v27, v114, v78, v27
    v_dot2_f32_bf16 v28, v115, v79, v28
    s_nop 2
    v_add_f32 v27, v27, v28
    s_nop 1
    v_add_f32_dpp v24, v24, v24 quad_perm:[1,0,3,2] row_mask:0xf bank_mask:0xf
    v_add_f32_dpp v25, v25, v25 quad_perm:[1,0,3,2] row_mask:0xf bank_mask:0xf
    v_add_f32_dpp v26, v26, v26 quad_perm:[1,0,3,2] row_mask:0xf bank_mask:0xf
    v_add_f32_dpp v27, v27, v27 quad_perm:[1,0,3,2] row_mask:0xf bank_mask:0xf
    v_add_f32_dpp v24, v24, v24 quad_perm:[2,3,0,1] row_mask:0xf bank_mask:0xf
    v_add_f32_dpp v25, v25, v25 quad_perm:[2,3,0,1] row_mask:0xf bank_mask:0xf
    v_add_f32_dpp v26, v26, v26 quad_perm:[2,3,0,1] row_mask:0xf bank_mask:0xf
    v_add_f32_dpp v27, v27, v27 quad_perm:[2,3,0,1] row_mask:0xf bank_mask:0xf
    v_add_f32_dpp v24, v24, v24 row_half_mirror row_mask:0xf bank_mask:0xf
    v_add_f32_dpp v25, v25, v25 row_half_mirror row_mask:0xf bank_mask:0xf
    v_add_f32_dpp v26, v26, v26 row_half_mirror row_mask:0xf bank_mask:0xf
    v_add_f32_dpp v27, v27, v27 row_half_mirror row_mask:0xf bank_mask:0xf
    v_mul_f32 v24, 0xbfb8aa3b, v24
    v_mul_f32 v25, 0xbfb8aa3b, v25
    v_mul_f32 v26, 0xbfb8aa3b, v26
    v_mul_f32 v27, 0xbfb8aa3b, v27
    v_exp_f32 v24, v24
    v_exp_f32 v25, v25
    v_exp_f32 v26, v26
    v_exp_f32 v27, v27
    v_add_f32 v24, 1.0, v24
    v_add_f32 v25, 1.0, v25
    v_add_f32 v26, 1.0, v26
    v_add_f32 v27, 1.0, v27
    v_rcp_f32 v24, v24
    v_rcp_f32 v25, v25
    v_rcp_f32 v26, v26
    v_rcp_f32 v27, v27
    v_cmp_eq_u32 vcc, 0, v32
    s_mov_b32 s70, 65536
    s_nop 0
    v_cndmask_b32 v20, v35, v20, vcc
    v_cndmask_b32 v21, v35, v21, vcc
    v_cndmask_b32 v22, v35, v22, vcc
    v_cndmask_b32 v23, v35, v23, vcc
    buffer_store_dword v24, v20, s[16:19], s70 offen sc1
    buffer_store_dword v25, v21, s[16:19], s70 offen sc1
    buffer_store_dword v26, v22, s[16:19], s70 offen sc1
    buffer_store_dword v27, v23, s[16:19], s70 offen sc1
    v_and_b32 v5, 1, v3
    v_lshlrev_b32 v5, 7, v5
    v_lshlrev_b32 v4, 4, v1
    v_xor_b32 v4, v4, v5
    s_mul_i32 s70, s4, 5
    s_add_u32 s70, s70, s6
    s_lshl_b32 s70, s70, 17
    s_add_u32 s70, s70, 1048576
    s_lshl_b32 s71, s3, 13
    s_add_u32 s70, s70, s71
    s_lshl_b32 s71, s6, 2
    s_add_u32 s71, s71, s3
    s_cmp_ge_u32 s71, 18
    s_cselect_b32 s71, 475136, 0
    s_sub_u32 s70, s70, s71
    v_add_u32 v13, s70, v4
    v_lshlrev_b32 v4, 3, v2
    v_lshl_add_u32 v4, v3, 8, v4
    v_add_u32 v15, v4, v5
    s_lshl_b32 s72, s6, 6
    v_add_u32 v116, s72, v2
    v_lshl_add_u32 v4, v3, 3, s66
    s_movk_i32 s70, 2560
    v_lshlrev_b32 v5, 3, v116
    v_mad_u32_u24 v117, v4, s70, v5
    v_add_u32 v117, 2621440, v117
    v_cmp_eq_u32 s[82:83], 0, v4
    v_add_u32 v5, 1310720, v117
    v_mov_b32 v6, 1073741824
    v_cndmask_b32 v118, v6, v5, s[82:83]
    v_cmp_eq_u32 vcc, 0, v2
    v_mov_b32 v5, 0xbf803f80
    s_mul_i32 s73, s4, 0x80008000
    v_cndmask_b32 v60, 0, v5, vcc
    s_sub_u32 s74, s4, 1
    v_mov_b32 v61, v60
    v_mov_b32 v62, v60
    v_mov_b32 v63, v60
    s_lshl_b32 s70, s6, 1
    s_add_u32 s71, s70, 1
    s_cmp_eq_u32 s71, 9
    s_cselect_b32 s71, 0, s71
    s_bitcmp1_b32 s3, 1
    s_cselect_b32 s70, s71, s70
    s_lshl_b32 s70, s70, 1
    s_and_b32 s71, s3, 1
    s_add_u32 s70, s70, s71
    s_mul_i32 s70, s70, 1664
    s_add_u32 s70, s70, 131072
    v_lshl_add_u32 v5, v1, 7, s70
    v_cmp_gt_u32 vcc, 13, v1
    s_nop 1
    v_cndmask_b32 v119, v6, v5, vcc
    s_lshl_b32 s60, s3, 15
    s_waitcnt lgkmcnt(0)
    s_add_u32 s7, s7, 0x9e3779b9
    buffer_load_dword v254, v255, s[8:11], s75 offen
    s_add_u32 s75, s75, 720896
    buffer_load_dword v254, v255, s[8:11], s75 offen
    s_add_u32 s75, s75, 720896
    s_mov_b32 s63, 1048576
    v_cmp_le_u32 s[80:81], 13, v1
L_pollAB:
    s_sleep 16
    buffer_load_dword v4, v119, s[16:19], 0 offen sc1
    s_sub_u32 s63, s63, 1
    s_waitcnt vmcnt(0)
    v_cmp_eq_u32 vcc, s7, v4
    s_cmp_eq_u32 s63, 0
    s_cbranch_scc1 L_pollAB_out
    s_or_b64 vcc, vcc, s[80:81]
    s_cmp_eq_u64 vcc, -1
    s_cbranch_scc0 L_pollAB
L_pollAB_out:
    s_barrier
    s_add_u32 m0, s60, 0
    s_mov_b32 s61, 0
    buffer_load_dwordx4 v13, s[16:19], s61 offen offset:0 sc1 lds
    buffer_load_dwordx4 v13, s[16:19], s61 offen offset:1024 sc1 lds
    buffer_load_dwordx4 v13, s[16:19], s61 offen offset:2048 sc1 lds
    buffer_load_dwordx4 v13, s[16:19], s61 offen offset:3072 sc1 lds
    s_add_u32 m0, s60, 4096
    s_mov_b32 s61, 4096
    buffer_load_dwordx4 v13, s[16:19], s61 offen offset:0 sc1 lds
    buffer_load_dwordx4 v13, s[16:19], s61 offen offset:1024 sc1 lds
    buffer_load_dwordx4 v13, s[16:19], s61 offen offset:2048 sc1 lds
    buffer_load_dwordx4 v13, s[16:19], s61 offen offset:3072 sc1 lds
    s_add_u32 m0, s60, 8192
    s_mov_b32 s61, 32768
    buffer_load_dwordx4 v13, s[16:19], s61 offen offset:0 sc1 lds
    buffer_load_dwordx4 v13, s[16:19], s61 offen offset:1024 sc1 lds
    buffer_load_dwordx4 v13, s[16:19], s61 offen offset:2048 sc1 lds
    buffer_load_dwordx4 v13, s[16:19], s61 offen offset:3072 sc1 lds
    s_add_u32 m0, s60, 12288
    s_mov_b32 s61, 36864
    buffer_load_dwordx4 v13, s[16:19], s61 offen offset:0 sc1 lds
    buffer_load_dwordx4 v13, s[16:19], s61 offen offset:1024 sc1 lds
    buffer_load_dwordx4 v13, s[16:19], s61 offen offset:2048 sc1 lds
    buffer_load_dwordx4 v13, s[16:19], s61 offen offset:3072 sc1 lds
    s_add_u32 m0, s60, 16384
    s_mov_b32 s61, 65536
    buffer_load_dwordx4 v13, s[16:19], s61 offen offset:0 sc1 lds
    buffer_load_dwordx4 v13, s[16:19], s61 offen offset:1024 sc1 lds
    buffer_load_dwordx4 v13, s[16:19], s61 offen offset:2048 sc1 lds
    buffer_load_dwordx4 v13, s[16:19], s61 offen offset:3072 sc1 lds
    s_add_u32 m0, s60, 20480
    s_mov_b32 s61, 69632
    buffer_load_dwordx4 v13, s[16:19], s61 offen offset:0 sc1 lds
    buffer_load_dwordx4 v13, s[16:19], s61 offen offset:1024 sc1 lds
    buffer_load_dwordx4 v13, s[16:19], s61 offen offset:2048 sc1 lds
    buffer_load_dwordx4 v13, s[16:19], s61 offen offset:3072 sc1 lds
    s_add_u32 m0, s60, 24576
    s_mov_b32 s61, 98304
    buffer_load_dwordx4 v13, s[16:19], s61 offen offset:0 sc1 lds
    buffer_load_dwordx4 v13, s[16:19], s61 offen offset:1024 sc1 lds
    buffer_load_dwordx4 v13, s[16:19], s61 offen offset:2048 sc1 lds
    buffer_load_dwordx4 v13, s[16:19], s61 offen offset:3072 sc1 lds
    s_add_u32 m0, s60, 28672
    s_mov_b32 s61, 102400
    buffer_load_dwordx4 v13, s[16:19], s61 offen offset:0 sc1 lds
    buffer_load_dwordx4 v13, s[16:19], s61 offen offset:1024 sc1 lds
    buffer_load_dwordx4 v13, s[16:19], s61 offen offset:2048 sc1 lds
    buffer_load_dwordx4 v13, s[16:19], s61 offen offset:3072 sc1 lds
    v_add_u32 v4, 0, v116
    v_cmp_eq_u32 vcc, 288, v4
    v_mov_b32 v5, 512
    s_mov_b32 s61, 77824
    v_cndmask_b32 v4, v4, v5, vcc
    v_lshlrev_b32 v4, 1, v4
    buffer_load_ushort v248, v4, s[16:19], s61 offen sc1
    v_add_u32 v4, 16, v116
    v_cmp_eq_u32 vcc, 288, v4
    v_mov_b32 v5, 512
    s_mov_b32 s61, 77824
    v_cndmask_b32 v4, v4, v5, vcc
    v_lshlrev_b32 v4, 1, v4
    buffer_load_ushort v249, v4, s[16:19], s61 offen sc1
    v_add_u32 v4, 32, v116
    v_cmp_eq_u32 vcc, 288, v4
    v_mov_b32 v5, 512
    s_mov_b32 s61, 77824
    v_cndmask_b32 v4, v4, v5, vcc
    v_lshlrev_b32 v4, 1, v4
    buffer_load_ushort v250, v4, s[16:19], s61 offen sc1
    v_add_u32 v4, 48, v116
    v_cmp_eq_u32 vcc, 288, v4
    v_mov_b32 v5, 512
    s_mov_b32 s61, 77824
    v_cndmask_b32 v4, v4, v5, vcc
    v_lshlrev_b32 v4, 1, v4
    buffer_load_ushort v251, v4, s[16:19], s61 offen sc1
    s_waitcnt vmcnt(0)
    s_barrier
    buffer_load_dword v254, v255, s[8:11], s75 offen
    s_add_u32 s75, s75, 720896
    buffer_load_dword v254, v255, s[8:11], s75 offen
    s_add_u32 s75, s75, 720896
    v_lshlrev_b32 v248, 16, v248
    v_and_b32 v248, s74, v248
    v_lshlrev_b32 v249, 16, v249
    v_and_b32 v249, s74, v249
    v_lshlrev_b32 v250, 16, v250
    v_and_b32 v250, s74, v250
    v_lshlrev_b32 v251, 16, v251
    v_and_b32 v251, s74, v251
    s_mov_b32 s63, 0
L_ct:
    s_lshl_b32 s70, s63, 15
    v_add_u32 v16, s70, v15
    v_xor_b32 v17, 128, v16
    v_xor_b32 v18, 0x80000000, v248
    ds_read_b64_tr_b16 v[100:101], v16 offset:0
    ds_read_b64_tr_b16 v[102:103], v17 offset:0
    ds_read_b64_tr_b16 v[104:105], v16 offset:1024
    ds_read_b64_tr_b16 v[106:107], v17 offset:1024
    ds_read_b64_tr_b16 v[108:109], v16 offset:2048
    ds_read_b64_tr_b16 v[110:111], v17 offset:2048
    buffer_load_dword v254, v255, s[8:11], s75 offen
    s_add_u32 s75, s75, 720896
    v_mov_b32 v64, v248
    v_mov_b32 v65, v18
    v_mov_b32 v66, v248
    v_mov_b32 v67, v18
    v_mov_b32 v80, v248
    v_mov_b32 v81, v18
    v_mov_b32 v82, v248
    v_mov_b32 v83, v18
    v_mov_b32 v96, v248
    v_mov_b32 v97, v248
    v_mov_b32 v98, v248
    v_mov_b32 v99, v248
    s_waitcnt lgkmcnt(4)
    v_mfma_f32_16x16x32_bf16 v[64:67], v[120:123], v[100:103], v[64:67]
    ds_read_b64_tr_b16 v[112:113], v16 offset:3072
    v_mfma_f32_16x16x32_bf16 v[80:83], a[0:3], v[100:103], v[80:83]
    ds_read_b64_tr_b16 v[114:115], v17 offset:3072
    v_mfma_f32_16x16x32_bf16 v[96:99], v[60:63], v[100:103], v[96:99]
    s_waitcnt lgkmcnt(4)
    v_mfma_f32_16x16x32_bf16 v[64:67], v[128:131], v[104:107], v[64:67]
    ds_read_b64_tr_b16 v[100:101], v16 offset:4096
    v_mfma_f32_16x16x32_bf16 v[80:83], a[8:11], v[104:107], v[80:83]
    ds_read_b64_tr_b16 v[102:103], v17 offset:4096
    v_mfma_f32_16x16x32_bf16 v[96:99], v[60:63], v[104:107], v[96:99]
    s_waitcnt lgkmcnt(4)
    v_mfma_f32_16x16x32_bf16 v[64:67], v[136:139], v[108:111], v[64:67]
    ds_read_b64_tr_b16 v[104:105], v16 offset:5120
    v_mfma_f32_16x16x32_bf16 v[80:83], a[16:19], v[108:111], v[80:83]
    ds_read_b64_tr_b16 v[106:107], v17 offset:5120
    v_mfma_f32_16x16x32_bf16 v[96:99], v[60:63], v[108:111], v[96:99]
    s_waitcnt lgkmcnt(4)
    v_mfma_f32_16x16x32_bf16 v[64:67], v[144:147], v[112:115], v[64:67]
    ds_read_b64_tr_b16 v[108:109], v16 offset:6144
    v_mfma_f32_16x16x32_bf16 v[80:83], a[24:27], v[112:115], v[80:83]
    ds_read_b64_tr_b16 v[110:111], v17 offset:6144
    v_mfma_f32_16x16x32_bf16 v[96:99], v[60:63], v[112:115], v[96:99]
    s_waitcnt lgkmcnt(4)
    v_mfma_f32_16x16x32_bf16 v[64:67], v[152:155], v[100:103], v[64:67]
    ds_read_b64_tr_b16 v[112:113], v16 offset:7168
    v_mfma_f32_16x16x32_bf16 v[80:83], a[32:35], v[100:103], v[80:83]
    ds_read_b64_tr_b16 v[114:115], v17 offset:7168
    v_mfma_f32_16x16x32_bf16 v[96:99], v[60:63], v[100:103], v[96:99]
    s_waitcnt lgkmcnt(4)
    v_mfma_f32_16x16x32_bf16 v[64:67], v[160:163], v[104:107], v[64:67]
    ds_read_b64_tr_b16 v[100:101], v16 offset:8192
    v_mfma_f32_16x16x32_bf16 v[80:83], a[40:43], v[104:107], v[80:83]
    ds_read_b64_tr_b16 v[102:103], v17 offset:8192
    v_mfma_f32_16x16x32_bf16 v[96:99], v[60:63], v[104:107], v[96:99]
    s_waitcnt lgkmcnt(4)
    v_mfma_f32_16x16x32_bf16 v[64:67], v[168:171], v[108:111], v[64:67]
    ds_read_b64_tr_b16 v[104:105], v16 offset:9216
    v_mfma_f32_16x16x32_bf16 v[80:83], a[48:51], v[108:111], v[80:83]
    ds_read_b64_tr_b16 v[106:107], v17 offset:9216
    v_mfma_f32_16x16x32_bf16 v[96:99], v[60:63], v[108:111], v[96:99]
    s_waitcnt lgkmcnt(4)
    v_mfma_f32_16x16x32_bf16 v[64:67], v[176:179], v[112:115], v[64:67]
    ds_read_b64_tr_b16 v[108:109], v16 offset:10240
    v_mfma_f32_16x16x32_bf16 v[80:83], a[56:59], v[112:115], v[80:83]
    ds_read_b64_tr_b16 v[110:111], v17 offset:10240
    v_mfma_f32_16x16x32_bf16 v[96:99], v[60:63], v[112:115], v[96:99]
    s_waitcnt lgkmcnt(4)
    v_mfma_f32_16x16x32_bf16 v[68:71], v[124:127], v[100:103], 0
    ds_read_b64_tr_b16 v[112:113], v16 offset:11264
    v_mfma_f32_16x16x32_bf16 v[84:87], a[4:7], v[100:103], 0
    ds_read_b64_tr_b16 v[114:115], v17 offset:11264
    s_waitcnt lgkmcnt(4)
    v_mfma_f32_16x16x32_bf16 v[68:71], v[132:135], v[104:107], v[68:71]
    ds_read_b64_tr_b16 v[100:101], v16 offset:12288
    v_mfma_f32_16x16x32_bf16 v[84:87], a[12:15], v[104:107], v[84:87]
    ds_read_b64_tr_b16 v[102:103], v17 offset:12288
    s_waitcnt lgkmcnt(4)
    v_mfma_f32_16x16x32_bf16 v[68:71], v[140:143], v[108:111], v[68:71]
    ds_read_b64_tr_b16 v[104:105], v16 offset:13312
    v_mfma_f32_16x16x32_bf16 v[84:87], a[20:23], v[108:111], v[84:87]
    ds_read_b64_tr_b16 v[106:107], v17 offset:13312
    s_waitcnt lgkmcnt(4)
    v_mfma_f32_16x16x32_bf16 v[68:71], v[148:151], v[112:115], v[68:71]
    ds_read_b64_tr_b16 v[108:109], v16 offset:14336
    v_mfma_f32_16x16x32_bf16 v[84:87], a[28:31], v[112:115], v[84:87]
    ds_read_b64_tr_b16 v[110:111], v17 offset:14336
    s_waitcnt lgkmcnt(4)
    v_mfma_f32_16x16x32_bf16 v[68:71], v[156:159], v[100:103], v[68:71]
    ds_read_b64_tr_b16 v[112:113], v16 offset:15360
    v_mfma_f32_16x16x32_bf16 v[84:87], a[36:39], v[100:103], v[84:87]
    ds_read_b64_tr_b16 v[114:115], v17 offset:15360
    s_waitcnt lgkmcnt(4)
    v_mfma_f32_16x16x32_bf16 v[68:71], v[164:167], v[104:107], v[68:71]
    ds_read_b64_tr_b16 v[100:101], v16 offset:16384
    v_mfma_f32_16x16x32_bf16 v[84:87], a[44:47], v[104:107], v[84:87]
    ds_read_b64_tr_b16 v[102:103], v17 offset:16384
    s_waitcnt lgkmcnt(4)
    v_mfma_f32_16x16x32_bf16 v[68:71], v[172:175], v[108:111], v[68:71]
    ds_read_b64_tr_b16 v[104:105], v16 offset:17408
    v_mfma_f32_16x16x32_bf16 v[84:87], a[52:55], v[108:111], v[84:87]
    ds_read_b64_tr_b16 v[106:107], v17 offset:17408
    s_waitcnt lgkmcnt(4)
    v_mfma_f32_16x16x32_bf16 v[68:71], v[180:183], v[112:115], v[68:71]
    ds_read_b64_tr_b16 v[108:109], v16 offset:18432
    v_mfma_f32_16x16x32_bf16 v[84:87], a[60:63], v[112:115], v[84:87]
    ds_read_b64_tr_b16 v[110:111], v17 offset:18432
    s_waitcnt lgkmcnt(4)
    v_mfma_f32_16x16x32_bf16 v[72:75], v[184:187], v[100:103], 0
    ds_read_b64_tr_b16 v[112:113], v16 offset:19456
    v_mfma_f32_16x16x32_bf16 v[88:91], a[64:67], v[100:103], 0
    ds_read_b64_tr_b16 v[114:115], v17 offset:19456
    s_waitcnt lgkmcnt(4)
    v_mfma_f32_16x16x32_bf16 v[72:75], v[192:195], v[104:107], v[72:75]
    ds_read_b64_tr_b16 v[100:101], v16 offset:20480
    v_mfma_f32_16x16x32_bf16 v[88:91], a[72:75], v[104:107], v[88:91]
    ds_read_b64_tr_b16 v[102:103], v17 offset:20480
    s_waitcnt lgkmcnt(4)
    v_mfma_f32_16x16x32_bf16 v[72:75], v[200:203], v[108:111], v[72:75]
    ds_read_b64_tr_b16 v[104:105], v16 offset:21504
    v_mfma_f32_16x16x32_bf16 v[88:91], a[80:83], v[108:111], v[88:91]
    ds_read_b64_tr_b16 v[106:107], v17 offset:21504
    s_waitcnt lgkmcnt(4)
    v_mfma_f32_16x16x32_bf16 v[72:75], v[208:211], v[112:115], v[72:75]
    ds_read_b64_tr_b16 v[108:109], v16 offset:22528
    v_mfma_f32_16x16x32_bf16 v[88:91], a[88:91], v[112:115], v[88:91]
    ds_read_b64_tr_b16 v[110:111], v17 offset:22528
    s_waitcnt lgkmcnt(4)
    v_mfma_f32_16x16x32_bf16 v[72:75], v[216:219], v[100:103], v[72:75]
    ds_read_b64_tr_b16 v[112:113], v16 offset:23552
    v_mfma_f32_16x16x32_bf16 v[88:91], a[96:99], v[100:103], v[88:91]
    ds_read_b64_tr_b16 v[114:115], v17 offset:23552
    s_waitcnt lgkmcnt(4)
    v_mfma_f32_16x16x32_bf16 v[72:75], v[224:227], v[104:107], v[72:75]
    ds_read_b64_tr_b16 v[100:101], v16 offset:24576
    v_mfma_f32_16x16x32_bf16 v[88:91], a[104:107], v[104:107], v[88:91]
    ds_read_b64_tr_b16 v[102:103], v17 offset:24576
    s_waitcnt lgkmcnt(4)
    v_mfma_f32_16x16x32_bf16 v[72:75], v[232:235], v[108:111], v[72:75]
    ds_read_b64_tr_b16 v[104:105], v16 offset:25600
    v_mfma_f32_16x16x32_bf16 v[88:91], a[112:115], v[108:111], v[88:91]
    ds_read_b64_tr_b16 v[106:107], v17 offset:25600
    s_waitcnt lgkmcnt(4)
    v_mfma_f32_16x16x32_bf16 v[72:75], v[240:243], v[112:115], v[72:75]
    ds_read_b64_tr_b16 v[108:109], v16 offset:26624
    v_mfma_f32_16x16x32_bf16 v[88:91], a[120:123], v[112:115], v[88:91]
    ds_read_b64_tr_b16 v[110:111], v17 offset:26624
    s_waitcnt lgkmcnt(4)
    v_mfma_f32_16x16x32_bf16 v[76:79], v[188:191], v[100:103], 0
    ds_read_b64_tr_b16 v[112:113], v16 offset:27648
    v_mfma_f32_16x16x32_bf16 v[92:95], a[68:71], v[100:103], 0
    ds_read_b64_tr_b16 v[114:115], v17 offset:27648
    s_waitcnt lgkmcnt(4)
    v_mfma_f32_16x16x32_bf16 v[76:79], v[196:199], v[104:107], v[76:79]
    ds_read_b64_tr_b16 v[100:101], v16 offset:28672
    v_mfma_f32_16x16x32_bf16 v[92:95], a[76:79], v[104:107], v[92:95]
    ds_read_b64_tr_b16 v[102:103], v17 offset:28672
    s_waitcnt lgkmcnt(4)
    v_mfma_f32_16x16x32_bf16 v[76:79], v[204:207], v[108:111], v[76:79]
    ds_read_b64_tr_b16 v[104:105], v16 offset:29696
    v_mfma_f32_16x16x32_bf16 v[92:95], a[84:87], v[108:111], v[92:95]
    ds_read_b64_tr_b16 v[106:107], v17 offset:29696
    s_waitcnt lgkmcnt(4)
    v_mfma_f32_16x16x32_bf16 v[76:79], v[212:215], v[112:115], v[76:79]
    ds_read_b64_tr_b16 v[108:109], v16 offset:30720
    v_mfma_f32_16x16x32_bf16 v[92:95], a[92:95], v[112:115], v[92:95]
    ds_read_b64_tr_b16 v[110:111], v17 offset:30720
    s_waitcnt lgkmcnt(4)
    v_mfma_f32_16x16x32_bf16 v[76:79], v[220:223], v[100:103], v[76:79]
    ds_read_b64_tr_b16 v[112:113], v16 offset:31744
    v_mfma_f32_16x16x32_bf16 v[92:95], a[100:103], v[100:103], v[92:95]
    ds_read_b64_tr_b16 v[114:115], v17 offset:31744
    s_waitcnt lgkmcnt(4)
    v_mfma_f32_16x16x32_bf16 v[76:79], v[228:231], v[104:107], v[76:79]
    v_mfma_f32_16x16x32_bf16 v[92:95], a[108:111], v[104:107], v[92:95]
    s_waitcnt lgkmcnt(2)
    v_mfma_f32_16x16x32_bf16 v[76:79], v[236:239], v[108:111], v[76:79]
    v_mfma_f32_16x16x32_bf16 v[92:95], a[116:119], v[108:111], v[92:95]
    s_waitcnt lgkmcnt(0)
    v_mfma_f32_16x16x32_bf16 v[76:79], v[244:247], v[112:115], v[76:79]
    v_mfma_f32_16x16x32_bf16 v[92:95], a[124:127], v[112:115], v[92:95]
    v_cmp_eq_u32 vcc, 0, v116
    v_mov_b32 v4, 288
    v_cmp_eq_u32 s[80:81], v4, v116
    v_mov_b32 v248, v249
    v_mov_b32 v249, v250
    v_mov_b32 v250, v251
    s_or_b64 vcc, vcc, s[80:81]
    s_nop 1
    v_cndmask_b32 v72, v72, 0, vcc
    v_cndmask_b32 v76, v76, 0, vcc
    v_add_f32 v20, v64, v68
    v_sub_f32 v21, v64, v68
    v_add_f32 v22, v72, v76
    v_sub_f32 v23, v76, v72
    v_sub_f32 v24, v20, v22
    v_add_f32 v25, v21, v23
    v_sub_f32 v26, v21, v23
    v_add_f32 v27, v20, v22
    v_sub_f32 v28, v96, v76
    v_add_f32 v29, v96, v76
    v_cndmask_b32 v24, v24, v20, s[82:83]
    v_cndmask_b32 v25, v25, v21, s[82:83]
    v_cndmask_b32 v26, v26, v28, s[82:83]
    v_cndmask_b32 v27, v27, v29, s[82:83]
    v_cvt_pk_bf16_f32 v30, v26, v27
    v_cvt_pk_bf16_f32 v31, v25, v24
    buffer_store_dwordx2 v[30:31], v118, s[16:19], 0 offen sc1
    v_cvt_pk_bf16_f32 v32, v24, v25
    v_cvt_pk_bf16_f32 v33, v26, v27
    s_mov_b32 s70, 0
    v_xor_b32 v32, s73, v32
    v_xor_b32 v33, s73, v33
    buffer_store_dwordx2 v[32:33], v117, s[16:19], s70 offen sc1
    v_cndmask_b32 v73, v73, 0, vcc
    v_cndmask_b32 v77, v77, 0, vcc
    v_add_f32 v20, v65, v69
    v_sub_f32 v21, v65, v69
    v_add_f32 v22, v73, v77
    v_sub_f32 v23, v77, v73
    v_sub_f32 v24, v20, v22
    v_add_f32 v25, v21, v23
    v_sub_f32 v26, v21, v23
    v_add_f32 v27, v20, v22
    v_cvt_pk_bf16_f32 v34, v24, v25
    v_cvt_pk_bf16_f32 v35, v26, v27
    s_mov_b32 s70, 5120
    v_xor_b32 v34, s73, v34
    v_xor_b32 v35, s73, v35
    buffer_store_dwordx2 v[34:35], v117, s[16:19], s70 offen sc1
    v_cndmask_b32 v74, v74, 0, vcc
    v_cndmask_b32 v78, v78, 0, vcc
    v_add_f32 v20, v66, v70
    v_sub_f32 v21, v66, v70
    v_add_f32 v22, v74, v78
    v_sub_f32 v23, v78, v74
    v_sub_f32 v24, v20, v22
    v_add_f32 v25, v21, v23
    v_sub_f32 v26, v21, v23
    v_add_f32 v27, v20, v22
    v_cvt_pk_bf16_f32 v36, v24, v25
    v_cvt_pk_bf16_f32 v37, v26, v27
    s_mov_b32 s70, 10240
    v_xor_b32 v36, s73, v36
    v_xor_b32 v37, s73, v37
    buffer_store_dwordx2 v[36:37], v117, s[16:19], s70 offen sc1
    v_cndmask_b32 v75, v75, 0, vcc
    v_cndmask_b32 v79, v79, 0, vcc
    v_add_f32 v20, v67, v71
    v_sub_f32 v21, v67, v71
    v_add_f32 v22, v75, v79
    v_sub_f32 v23, v79, v75
    v_sub_f32 v24, v20, v22
    v_add_f32 v25, v21, v23
    v_sub_f32 v26, v21, v23
    v_add_f32 v27, v20, v22
    v_cvt_pk_bf16_f32 v38, v24, v25
    v_cvt_pk_bf16_f32 v39, v26, v27
    s_mov_b32 s70, 15360
    v_xor_b32 v38, s73, v38
    v_xor_b32 v39, s73, v39
    buffer_store_dwordx2 v[38:39], v117, s[16:19], s70 offen sc1
    v_cndmask_b32 v88, v88, 0, vcc
    v_cndmask_b32 v92, v92, 0, vcc
    v_add_f32 v20, v80, v84
    v_sub_f32 v21, v80, v84
    v_add_f32 v22, v88, v92
    v_sub_f32 v23, v92, v88
    v_sub_f32 v24, v20, v22
    v_add_f32 v25, v21, v23
    v_sub_f32 v26, v21, v23
    v_add_f32 v27, v20, v22
    v_cvt_pk_bf16_f32 v40, v24, v25
    v_cvt_pk_bf16_f32 v41, v26, v27
    s_mov_b32 s70, 81920
    v_xor_b32 v40, s73, v40
    v_xor_b32 v41, s73, v41
    buffer_store_dwordx2 v[40:41], v117, s[16:19], s70 offen sc1
    v_cndmask_b32 v89, v89, 0, vcc
    v_cndmask_b32 v93, v93, 0, vcc
    v_add_f32 v20, v81, v85
    v_sub_f32 v21, v81, v85
    v_add_f32 v22, v89, v93
    v_sub_f32 v23, v93, v89
    v_sub_f32 v24, v20, v22
    v_add_f32 v25, v21, v23
    v_sub_f32 v26, v21, v23
    v_add_f32 v27, v20, v22
    v_cvt_pk_bf16_f32 v42, v24, v25
    v_cvt_pk_bf16_f32 v43, v26, v27
    s_mov_b32 s70, 87040
    v_xor_b32 v42, s73, v42
    v_xor_b32 v43, s73, v43
    buffer_store_dwordx2 v[42:43], v117, s[16:19], s70 offen sc1
    v_cndmask_b32 v90, v90, 0, vcc
    v_cndmask_b32 v94, v94, 0, vcc
    v_add_f32 v20, v82, v86
    v_sub_f32 v21, v82, v86
    v_add_f32 v22, v90, v94
    v_sub_f32 v23, v94, v90
    v_sub_f32 v24, v20, v22
    v_add_f32 v25, v21, v23
    v_sub_f32 v26, v21, v23
    v_add_f32 v27, v20, v22
    v_cvt_pk_bf16_f32 v44, v24, v25
    v_cvt_pk_bf16_f32 v45, v26, v27
    s_mov_b32 s70, 92160
    v_xor_b32 v44, s73, v44
    v_xor_b32 v45, s73, v45
    buffer_store_dwordx2 v[44:45], v117, s[16:19], s70 offen sc1
    v_cndmask_b32 v91, v91, 0, vcc
    v_cndmask_b32 v95, v95, 0, vcc
    v_add_f32 v20, v83, v87
    v_sub_f32 v21, v83, v87
    v_add_f32 v22, v91, v95
    v_sub_f32 v23, v95, v91
    v_sub_f32 v24, v20, v22
    v_add_f32 v25, v21, v23
    v_sub_f32 v26, v21, v23
    v_add_f32 v27, v20, v22
    v_cvt_pk_bf16_f32 v46, v24, v25
    v_cvt_pk_bf16_f32 v47, v26, v27
    s_mov_b32 s70, 97280
    v_xor_b32 v46, s73, v46
    v_xor_b32 v47, s73, v47
    buffer_store_dwordx2 v[46:47], v117, s[16:19], s70 offen sc1
    v_add_u32 v116, 16, v116
    v_add_u32 v117, 128, v117
    v_add_u32 v118, 128, v118
    s_add_u32 s63, s63, 1
    s_cmp_lt_u32 s63, 4
    s_cbranch_scc1 L_ct
    s_waitcnt vmcnt(0)
    s_barrier
    s_lshl_b32 s70, s64, 2
    s_add_u32 s70, s70, 40960
    v_cmp_gt_u32 vcc, 26, v0
    v_mov_b32 v4, 1073741824
    v_lshlrev_b32 v6, 7, v0
    v_mov_b32 v5, s7
    v_cndmask_b32 v4, v4, v6, vcc
    buffer_store_dword v5, v4, s[16:19], s70 offen sc1
L_end:
    s_endpgm
L_idle:
    buffer_load_dword v254, v253, s[12:15], s76 offen
    s_add_u32 s76, s76, 128
    buffer_load_dword v254, v253, s[12:15], s76 offen
    s_add_u32 s76, s76, 128
    buffer_load_dword v254, v253, s[12:15], s76 offen
    s_add_u32 s76, s76, 128
    buffer_load_dword v254, v253, s[12:15], s76 offen
    s_add_u32 s76, s76, 128
    buffer_load_dword v254, v253, s[12:15], s76 offen
    s_add_u32 s76, s76, 128
    buffer_load_dword v254, v253, s[12:15], s76 offen
    s_add_u32 s76, s76, 128
    buffer_load_dword v254, v255, s[8:11], s75 offen
    s_add_u32 s75, s75, 720896
    buffer_load_dword v254, v255, s[8:11], s75 offen
    s_add_u32 s75, s75, 720896
    buffer_load_dword v254, v255, s[8:11], s75 offen
    s_add_u32 s75, s75, 720896
    buffer_load_dword v254, v255, s[8:11], s75 offen
    s_add_u32 s75, s75, 720896
    buffer_load_dword v254, v255, s[8:11], s75 offen
    s_add_u32 s75, s75, 720896
    buffer_load_dword v254, v255, s[8:11], s75 offen
    s_add_u32 s75, s75, 720896
    buffer_load_dword v254, v255, s[8:11], s75 offen
    s_add_u32 s75, s75, 720896
    buffer_load_dword v254, v255, s[8:11], s75 offen
    s_add_u32 s75, s75, 720896
    s_endpgm
.section .rodata,"a"
.p2align 6
.amdhsa_kernel gated_mix__spectral_fnet__dense_activation_relu__prompt_kernel
  .amdhsa_next_free_vgpr 512
  .amdhsa_next_free_sgpr 102
  .amdhsa_accum_offset 256
  .amdhsa_group_segment_fixed_size 0
  .amdhsa_kernarg_size 96
  .amdhsa_user_sgpr_count 2
  .amdhsa_user_sgpr_kernarg_segment_ptr 1
  .amdhsa_system_sgpr_workgroup_id_x 1
.end_amdhsa_kernel
```
